```python
import torch

def _softmax(x, axis=-1):
    return torch.softmax(x, dim=axis)
def _gelu(x):
    return torch.nn.functional.gelu(x, approximate="tanh")
def _silu(x):
    return torch.nn.functional.silu(x)
def _sigmoid(x):
    return torch.sigmoid(x)
def _layernorm(x, axis=-1, eps=1e-5):
    m = x.mean(dim=axis, keepdim=True)
    v = x.var(dim=axis, keepdim=True, unbiased=False)
    return (x - m) / torch.sqrt(v + eps)
def _scatter_add(tgt, idx, src, axis=0):
    return tgt.clone().index_add_(axis, idx, src)
def _segment_sum(src, seg, n):
    out = torch.zeros((n,) + src.shape[1:], dtype=src.dtype)
    return out.index_add_(0, seg, src)
def _pad(x, pw):
    flat = tuple(v for pair in reversed(pw) for v in pair)
    return torch.nn.functional.pad(x, flat)

kernel_name = 'sequential_preLN__sliding_block__glu_gated_glu__prompt'

def setup_inputs():

    _w = (lambda a: (lambda t: t.to(torch.bfloat16) if t.is_floating_point() else t)(torch.as_tensor(a)))
    def _A_setup():
        B, S, D = 1, 2048, 512
        return {
            "x": _w((lambda *s: torch.randn(*s, dtype=torch.bfloat16) * 0.05)(B, S, D)),
            "wqkv": _w((lambda *s: torch.randn(*s, dtype=torch.bfloat16) * 0.05)(D, 3 * D)),
            "wo": _w((lambda *s: torch.randn(*s, dtype=torch.bfloat16) * 0.05)(D, D)),
        }
    _A_in = _A_setup()

    def _B_setup():
        B, S, D, F = 1, 2048, 512, 1376
        return {
            "x": _w((lambda *s: torch.randn(*s, dtype=torch.bfloat16) * 0.05)(B, S, D)),
            "w_gate": _w((lambda *s: torch.randn(*s, dtype=torch.bfloat16) * 0.05)(D, F)),
            "w_up": _w((lambda *s: torch.randn(*s, dtype=torch.bfloat16) * 0.05)(D, F)),
            "w_down": _w((lambda *s: torch.randn(*s, dtype=torch.bfloat16) * 0.05)(F, D)),
        }
    _B_in = _B_setup()

    return {
        "A_x": _A_in["x"],
        "A_wqkv": _A_in["wqkv"],
        "A_wo": _A_in["wo"],
        "B_x": _B_in["x"],
        "B_w_gate": _B_in["w_gate"],
        "B_w_up": _B_in["w_up"],
        "B_w_down": _B_in["w_down"],
    }

def reference(A_x, A_wqkv, A_wo, B_x, B_w_gate, B_w_up, B_w_down):
    def _A_ref(x, wqkv, wo):
        B, S, D = x.shape
        H = 32; Dh = D // H; W = 256
        qkv = (lambda x, *d: x.permute(*d))((x @ wqkv).reshape(B, S, 3, H, Dh), 2, 0, 3, 1, 4)
        q, k, v = qkv[0], qkv[1], qkv[2]
        scores = torch.einsum("bhqd,bhkd->bhqk", q, k) * (Dh ** -0.5)
        idx = torch.arange(S)
        mask = (idx[:, None] - idx[None, :] >= 0) & (idx[:, None] - idx[None, :] < W)
        scores = torch.where(mask[None, None], scores, -1e9)
        p = _softmax(scores, axis=-1)
        o = torch.einsum("bhqk,bhkd->bhqd", p, v)
        return (lambda x, *d: x.permute(*d))(o, 0, 2, 1, 3).reshape(B, S, D) @ wo

    def _B_ref(x, w_gate, w_up, w_down):
        g = torch.einsum("bsd,df->bsf", x, w_gate)
        u = torch.einsum("bsd,df->bsf", x, w_up)
        h = _sigmoid(g) * u
        return torch.einsum("bsf,fd->bsd", h, w_down)

    x = A_x
    h = x + _A_ref(_layernorm(x, axis=-1), A_wqkv, A_wo)
    h2 = h + _B_ref(_layernorm(h, axis=-1), B_w_gate, B_w_up, B_w_down)
    return h2
```

```asm
; @launch kernel=k_qkv_kernel grid=(256,1,1) block=(512,1,1) lds=163840
; @launch kernel=k_attn_kernel grid=(512,1,1) block=(512,1,1) lds=24576
; @launch kernel=k_wo_kernel grid=(256,1,1) block=(512,1,1) lds=131072
; @launch kernel=k_gu_kernel grid=(256,1,1) block=(512,1,1) lds=163840
; @launch kernel=k_down_kernel grid=(256,1,1) block=(512,1,1) lds=131072
.amdgcn_target "amdgcn-amd-amdhsa--gfx950"
.text
.globl k_qkv_kernel
.p2align 8
.type k_qkv_kernel,@function
k_qkv_kernel:
    s_cmp_ge_u32 s2, 256
    s_cbranch_scc1 k_qkv_kernel_done
    s_load_dwordx4 s[32:35], s[0:1], 0
    s_load_dwordx4 s[36:39], s[0:1], 32
    s_load_dwordx2 s[40:41], s[0:1], 72
    v_lshrrev_b32 v1, 6, v0
    v_and_b32 v2, 63, v0
    s_nop 0
    v_readfirstlane_b32 s20, v1
    s_and_b32 s22, s2, 3
    s_lshl_b32 s22, s22, 3
    s_bfe_u32 s21, s2, 0x30003
    s_add_u32 s22, s22, s21
    s_bfe_u32 s21, s2, 0x10002
    s_lshl_b32 s21, s21, 2
    s_lshr_b32 s100, s2, 6
    s_add_u32 s21, s21, s100
    s_lshr_b32 s23, s20, 2
    s_and_b32 s24, s20, 3
    s_waitcnt lgkmcnt(0)
    s_mov_b32 s8, s32
    s_mov_b32 s9, s33
    s_mov_b32 s10, 2097152
    s_mov_b32 s11, 0x00020000
    s_mov_b32 s12, s34
    s_mov_b32 s13, s35
    s_mov_b32 s14, 1572864
    s_mov_b32 s15, 0x00020000
    s_mov_b32 s16, s40
    s_mov_b32 s17, s41
    s_mov_b32 s18, 6291456
    s_mov_b32 s19, 0x00020000
    v_lshrrev_b32 v4, 3, v2
    v_and_b32 v5, 7, v2
    s_lshl_b32 s27, s20, 3
    v_add_u32 v6, s27, v4
    v_lshlrev_b32 v3, 10, v6
    v_lshl_add_u32 v3, v5, 4, v3
    s_lshl_b32 s27, s22, 16
    buffer_load_dwordx4 v[176:179], v3, s[8:11], s27 offen offset:0
    buffer_load_dwordx4 v[180:183], v3, s[8:11], s27 offen offset:128
    buffer_load_dwordx4 v[184:187], v3, s[8:11], s27 offen offset:256
    buffer_load_dwordx4 v[188:191], v3, s[8:11], s27 offen offset:384
    buffer_load_dwordx4 v[192:195], v3, s[8:11], s27 offen offset:512
    buffer_load_dwordx4 v[196:199], v3, s[8:11], s27 offen offset:640
    buffer_load_dwordx4 v[200:203], v3, s[8:11], s27 offen offset:768
    buffer_load_dwordx4 v[204:207], v3, s[8:11], s27 offen offset:896
    s_mul_i32 s28, s24, 192
    v_add_u32 v11, s28, v2
    v_mul_u32_u24 v12, 2731, v11
    v_lshrrev_b32 v12, 16, v12
    v_mul_u32_u24 v13, 24, v12
    v_sub_u32 v13, v11, v13
    v_bfe_u32 v14, v12, 1, 1
    v_bfe_u32 v15, v12, 3, 1
    v_lshl_or_b32 v14, v15, 1, v14
    v_lshlrev_b32 v14, 1, v14
    v_xor_b32 v13, v13, v14
    s_mov_b32 s27, 3072
    v_mul_lo_u32 v12, v12, s27
    v_lshl_add_u32 v8, v13, 4, v12
    v_add_u32 v11, s28, v2
    v_add_u32 v11, 64, v11
    v_mul_u32_u24 v12, 2731, v11
    v_lshrrev_b32 v12, 16, v12
    v_mul_u32_u24 v13, 24, v12
    v_sub_u32 v13, v11, v13
    v_bfe_u32 v14, v12, 1, 1
    v_bfe_u32 v15, v12, 3, 1
    v_lshl_or_b32 v14, v15, 1, v14
    v_lshlrev_b32 v14, 1, v14
    v_xor_b32 v13, v13, v14
    s_mov_b32 s27, 3072
    v_mul_lo_u32 v12, v12, s27
    v_lshl_add_u32 v9, v13, 4, v12
    v_add_u32 v11, s28, v2
    v_add_u32 v11, 128, v11
    v_mul_u32_u24 v12, 2731, v11
    v_lshrrev_b32 v12, 16, v12
    v_mul_u32_u24 v13, 24, v12
    v_sub_u32 v13, v11, v13
    v_bfe_u32 v14, v12, 1, 1
    v_bfe_u32 v15, v12, 3, 1
    v_lshl_or_b32 v14, v15, 1, v14
    v_lshlrev_b32 v14, 1, v14
    v_xor_b32 v13, v13, v14
    s_mov_b32 s27, 3072
    v_mul_lo_u32 v12, v12, s27
    v_lshl_add_u32 v10, v13, 4, v12
    s_mul_i32 s26, s21, 384
    s_mul_i32 s27, s23, 98304
    s_add_u32 s26, s26, s27
    s_mul_i32 s25, s20, 3072
    s_add_u32 s25, s25, 65536
    s_add_u32 m0, s25, 0
    s_nop 0
    buffer_load_dwordx4 v8, s[12:15], s26 offen  lds
    s_add_u32 m0, s25, 1024
    s_nop 0
    buffer_load_dwordx4 v9, s[12:15], s26 offen  lds
    s_add_u32 m0, s25, 2048
    s_nop 0
    buffer_load_dwordx4 v10, s[12:15], s26 offen  lds
    s_add_u32 s26, s26, 196608
    v_mov_b32 v28, v4
    v_mov_b32 v29, v5
    v_mov_b32 v30, v6
    v_and_b32 v4, 15, v2
    v_lshrrev_b32 v5, 4, v2
    s_lshl_b32 s27, s23, 15
    v_lshlrev_b32 v6, 10, v4
    v_add_u32 v6, s27, v6
    v_and_b32 v7, 3, v4
    v_xor_b32 v7, v7, v5
    v_lshrrev_b32 v11, 2, v4
    v_xor_b32 v12, 0, v11
    v_lshl_or_b32 v12, v12, 2, v7
    v_lshl_add_u32 v24, v12, 4, v6
    v_xor_b32 v12, 1, v11
    v_lshl_or_b32 v12, v12, 2, v7
    v_lshl_add_u32 v25, v12, 4, v6
    v_xor_b32 v12, 2, v11
    v_lshl_or_b32 v12, v12, 2, v7
    v_lshl_add_u32 v26, v12, 4, v6
    v_xor_b32 v12, 3, v11
    v_lshl_or_b32 v12, v12, 2, v7
    v_lshl_add_u32 v27, v12, 4, v6
    v_lshrrev_b32 v11, 2, v4
    v_and_b32 v12, 3, v4
    v_lshl_add_u32 v13, v5, 3, v11
    v_mul_u32_u24 v13, 384, v13
    v_lshl_add_u32 v13, v12, 3, v13
    v_add_u32 v13, 65536, v13
    v_lshrrev_b32 v14, 1, v11
    v_and_b32 v15, 1, v5
    v_lshl_or_b32 v14, v15, 1, v14
    s_mul_i32 s27, s24, 3
    s_add_u32 s28, s27, 0
    v_xor_b32 v15, s28, v14
    v_lshl_add_u32 v16, v15, 5, v13
    v_add_u32 v19, 49152, v16
    s_add_u32 s28, s27, 1
    v_xor_b32 v15, s28, v14
    v_lshl_add_u32 v17, v15, 5, v13
    v_add_u32 v20, 49152, v17
    s_add_u32 s28, s27, 2
    v_xor_b32 v15, s28, v14
    v_lshl_add_u32 v18, v15, 5, v13
    v_add_u32 v21, 49152, v18
    v_mov_b32 v128, 0
    v_mov_b32 v129, 0
    v_mov_b32 v130, 0
    v_mov_b32 v131, 0
    v_mov_b32 v132, 0
    v_mov_b32 v133, 0
    v_mov_b32 v134, 0
    v_mov_b32 v135, 0
    v_mov_b32 v136, 0
    v_mov_b32 v137, 0
    v_mov_b32 v138, 0
    v_mov_b32 v139, 0
    v_mov_b32 v140, 0
    v_mov_b32 v141, 0
    v_mov_b32 v142, 0
    v_mov_b32 v143, 0
    v_mov_b32 v144, 0
    v_mov_b32 v145, 0
    v_mov_b32 v146, 0
    v_mov_b32 v147, 0
    v_mov_b32 v148, 0
    v_mov_b32 v149, 0
    v_mov_b32 v150, 0
    v_mov_b32 v151, 0
    s_waitcnt vmcnt(3)
    s_mov_b32 s31, 0x3f803f80
    v_dot2_f32_bf16 v214, v176, s31, 0
    v_dot2_f32_bf16 v215, v177, s31, 0
    v_dot2_f32_bf16 v216, v176, v176, 0
    v_dot2_f32_bf16 v217, v177, v177, 0
    v_dot2_f32_bf16 v214, v178, s31, v214
    v_dot2_f32_bf16 v215, v179, s31, v215
    v_dot2_f32_bf16 v216, v178, v178, v216
    v_dot2_f32_bf16 v217, v179, v179, v217
    v_dot2_f32_bf16 v214, v180, s31, v214
    v_dot2_f32_bf16 v215, v181, s31, v215
    v_dot2_f32_bf16 v216, v180, v180, v216
    v_dot2_f32_bf16 v217, v181, v181, v217
    v_dot2_f32_bf16 v214, v182, s31, v214
    v_dot2_f32_bf16 v215, v183, s31, v215
    v_dot2_f32_bf16 v216, v182, v182, v216
    v_dot2_f32_bf16 v217, v183, v183, v217
    v_dot2_f32_bf16 v214, v184, s31, v214
    v_dot2_f32_bf16 v215, v185, s31, v215
    v_dot2_f32_bf16 v216, v184, v184, v216
    v_dot2_f32_bf16 v217, v185, v185, v217
    v_dot2_f32_bf16 v214, v186, s31, v214
    v_dot2_f32_bf16 v215, v187, s31, v215
    v_dot2_f32_bf16 v216, v186, v186, v216
    v_dot2_f32_bf16 v217, v187, v187, v217
    v_dot2_f32_bf16 v214, v188, s31, v214
    v_dot2_f32_bf16 v215, v189, s31, v215
    v_dot2_f32_bf16 v216, v188, v188, v216
    v_dot2_f32_bf16 v217, v189, v189, v217
    v_dot2_f32_bf16 v214, v190, s31, v214
    v_dot2_f32_bf16 v215, v191, s31, v215
    v_dot2_f32_bf16 v216, v190, v190, v216
    v_dot2_f32_bf16 v217, v191, v191, v217
    v_dot2_f32_bf16 v214, v192, s31, v214
    v_dot2_f32_bf16 v215, v193, s31, v215
    v_dot2_f32_bf16 v216, v192, v192, v216
    v_dot2_f32_bf16 v217, v193, v193, v217
    v_dot2_f32_bf16 v214, v194, s31, v214
    v_dot2_f32_bf16 v215, v195, s31, v215
    v_dot2_f32_bf16 v216, v194, v194, v216
    v_dot2_f32_bf16 v217, v195, v195, v217
    v_dot2_f32_bf16 v214, v196, s31, v214
    v_dot2_f32_bf16 v215, v197, s31, v215
    v_dot2_f32_bf16 v216, v196, v196, v216
    v_dot2_f32_bf16 v217, v197, v197, v217
    v_dot2_f32_bf16 v214, v198, s31, v214
    v_dot2_f32_bf16 v215, v199, s31, v215
    v_dot2_f32_bf16 v216, v198, v198, v216
    v_dot2_f32_bf16 v217, v199, v199, v217
    v_dot2_f32_bf16 v214, v200, s31, v214
    v_dot2_f32_bf16 v215, v201, s31, v215
    v_dot2_f32_bf16 v216, v200, v200, v216
    v_dot2_f32_bf16 v217, v201, v201, v217
    v_dot2_f32_bf16 v214, v202, s31, v214
    v_dot2_f32_bf16 v215, v203, s31, v215
    v_dot2_f32_bf16 v216, v202, v202, v216
    v_dot2_f32_bf16 v217, v203, v203, v217
    v_dot2_f32_bf16 v214, v204, s31, v214
    v_dot2_f32_bf16 v215, v205, s31, v215
    v_dot2_f32_bf16 v216, v204, v204, v216
    v_dot2_f32_bf16 v217, v205, v205, v217
    v_dot2_f32_bf16 v214, v206, s31, v214
    v_dot2_f32_bf16 v215, v207, s31, v215
    v_dot2_f32_bf16 v216, v206, v206, v216
    v_dot2_f32_bf16 v217, v207, v207, v217
    s_nop 3
    v_add_f32 v214, v214, v215
    v_add_f32 v216, v216, v217
    s_nop 1
    v_add_f32_dpp v214, v214, v214 quad_perm:[1,0,3,2] row_mask:0xf bank_mask:0xf
    v_add_f32_dpp v216, v216, v216 quad_perm:[1,0,3,2] row_mask:0xf bank_mask:0xf
    s_nop 1
    v_add_f32_dpp v214, v214, v214 quad_perm:[2,3,0,1] row_mask:0xf bank_mask:0xf
    v_add_f32_dpp v216, v216, v216 quad_perm:[2,3,0,1] row_mask:0xf bank_mask:0xf
    s_nop 1
    v_add_f32_dpp v214, v214, v214 row_half_mirror row_mask:0xf bank_mask:0xf
    v_add_f32_dpp v216, v216, v216 row_half_mirror row_mask:0xf bank_mask:0xf
    s_add_u32 m0, s25, 24576
    s_nop 0
    buffer_load_dwordx4 v8, s[12:15], s26 offen  lds
    s_add_u32 m0, s25, 25600
    s_nop 0
    buffer_load_dwordx4 v9, s[12:15], s26 offen  lds
    s_add_u32 m0, s25, 26624
    s_nop 0
    buffer_load_dwordx4 v10, s[12:15], s26 offen  lds
    s_add_u32 s26, s26, 196608
    v_mul_f32 v214, 0x3b000000, v214
    v_mul_f32 v216, 0x3b000000, v216
    v_fma_f32 v216, -v214, v214, v216
    v_max_f32 v216, 0, v216
    v_add_f32 v216, 0x3727c5ac, v216
    v_rsq_f32 v208, v216
    s_nop 0
    v_mul_f32 v209, v214, v208
    v_sub_f32 v209, 0, v209
    v_xor_b32 v218, v28, v29
    s_and_b32 s27, s20, 1
    s_lshl_b32 s27, s27, 3
    v_add_u32 v219, s27, v218
    s_xor_b32 s27, s27, 8
    v_add_u32 v220, s27, v218
    v_lshlrev_b32 v210, 10, v30
    v_lshl_add_u32 v211, v220, 4, v210
    v_lshl_add_u32 v210, v219, 4, v210
    v_lshlrev_b32 v212, 16, v176
    v_and_b32 v213, 0xffff0000, v176
    v_fma_f32 v212, v212, v208, v209
    v_fma_f32 v213, v213, v208, v209
    v_cvt_pk_bf16_f32 v176, v212, v213
    v_lshlrev_b32 v212, 16, v177
    v_and_b32 v213, 0xffff0000, v177
    v_fma_f32 v212, v212, v208, v209
    v_fma_f32 v213, v213, v208, v209
    v_cvt_pk_bf16_f32 v177, v212, v213
    v_lshlrev_b32 v212, 16, v178
    v_and_b32 v213, 0xffff0000, v178
    v_fma_f32 v212, v212, v208, v209
    v_fma_f32 v213, v213, v208, v209
    v_cvt_pk_bf16_f32 v178, v212, v213
    v_lshlrev_b32 v212, 16, v179
    v_and_b32 v213, 0xffff0000, v179
    v_fma_f32 v212, v212, v208, v209
    v_fma_f32 v213, v213, v208, v209
    v_cvt_pk_bf16_f32 v179, v212, v213
    ds_write_b128 v210, v[176:179] offset:0
    v_lshlrev_b32 v212, 16, v180
    v_and_b32 v213, 0xffff0000, v180
    v_fma_f32 v212, v212, v208, v209
    v_fma_f32 v213, v213, v208, v209
    v_cvt_pk_bf16_f32 v180, v212, v213
    v_lshlrev_b32 v212, 16, v181
    v_and_b32 v213, 0xffff0000, v181
    v_fma_f32 v212, v212, v208, v209
    v_fma_f32 v213, v213, v208, v209
    v_cvt_pk_bf16_f32 v181, v212, v213
    v_lshlrev_b32 v212, 16, v182
    v_and_b32 v213, 0xffff0000, v182
    v_fma_f32 v212, v212, v208, v209
    v_fma_f32 v213, v213, v208, v209
    v_cvt_pk_bf16_f32 v182, v212, v213
    v_lshlrev_b32 v212, 16, v183
    v_and_b32 v213, 0xffff0000, v183
    v_fma_f32 v212, v212, v208, v209
    v_fma_f32 v213, v213, v208, v209
    v_cvt_pk_bf16_f32 v183, v212, v213
    ds_write_b128 v211, v[180:183] offset:0
    s_waitcnt vmcnt(3) lgkmcnt(0)
    s_barrier
    ds_read_b128 v[32:35], v24 offset:0
    ds_read_b128 v[36:39], v24 offset:16384
    ds_read_b128 v[40:43], v25 offset:0
    ds_read_b128 v[44:47], v25 offset:16384
    ds_read_b64_tr_b16 v[48:49], v16 offset:0
    ds_read_b64_tr_b16 v[50:51], v16 offset:1536
    ds_read_b64_tr_b16 v[52:53], v17 offset:0
    ds_read_b64_tr_b16 v[54:55], v17 offset:1536
    ds_read_b64_tr_b16 v[56:57], v18 offset:0
    ds_read_b64_tr_b16 v[58:59], v18 offset:1536
    ds_read_b64_tr_b16 v[60:61], v16 offset:12288
    ds_read_b64_tr_b16 v[62:63], v16 offset:13824
    ds_read_b64_tr_b16 v[64:65], v17 offset:12288
    ds_read_b64_tr_b16 v[66:67], v17 offset:13824
    ds_read_b64_tr_b16 v[68:69], v18 offset:12288
    ds_read_b64_tr_b16 v[70:71], v18 offset:13824
    s_add_u32 m0, s25, 49152
    s_nop 0
    buffer_load_dwordx4 v8, s[12:15], s26 offen  lds
    s_add_u32 m0, s25, 50176
    s_nop 0
    buffer_load_dwordx4 v9, s[12:15], s26 offen  lds
    s_add_u32 m0, s25, 51200
    s_nop 0
    buffer_load_dwordx4 v10, s[12:15], s26 offen  lds
    s_add_u32 s26, s26, 196608
    v_lshlrev_b32 v212, 16, v184
    v_and_b32 v213, 0xffff0000, v184
    v_fma_f32 v212, v212, v208, v209
    v_fma_f32 v213, v213, v208, v209
    v_cvt_pk_bf16_f32 v184, v212, v213
    v_lshlrev_b32 v212, 16, v185
    v_and_b32 v213, 0xffff0000, v185
    v_fma_f32 v212, v212, v208, v209
    v_fma_f32 v213, v213, v208, v209
    v_cvt_pk_bf16_f32 v185, v212, v213
    v_lshlrev_b32 v212, 16, v186
    v_and_b32 v213, 0xffff0000, v186
    v_fma_f32 v212, v212, v208, v209
    v_fma_f32 v213, v213, v208, v209
    v_cvt_pk_bf16_f32 v186, v212, v213
    v_lshlrev_b32 v212, 16, v187
    v_and_b32 v213, 0xffff0000, v187
    v_fma_f32 v212, v212, v208, v209
    v_fma_f32 v213, v213, v208, v209
    v_cvt_pk_bf16_f32 v187, v212, v213
    ds_write_b128 v210, v[184:187] offset:256
    s_waitcnt vmcnt(3) lgkmcnt(0)
    s_barrier
    v_mfma_f32_16x16x32_bf16 v[128:131], v[48:51], v[32:35], v[128:131]
    ds_read_b128 v[80:83], v26 offset:0
    ds_read_b128 v[84:87], v26 offset:16384
    ds_read_b128 v[88:91], v27 offset:0
    v_mfma_f32_16x16x32_bf16 v[140:143], v[48:51], v[36:39], v[140:143]
    ds_read_b128 v[92:95], v27 offset:16384
    ds_read_b64_tr_b16 v[96:97], v16 offset:24576
    ds_read_b64_tr_b16 v[98:99], v16 offset:26112
    v_mfma_f32_16x16x32_bf16 v[132:135], v[52:55], v[32:35], v[132:135]
    ds_read_b64_tr_b16 v[100:101], v17 offset:24576
    ds_read_b64_tr_b16 v[102:103], v17 offset:26112
    ds_read_b64_tr_b16 v[104:105], v18 offset:24576
    ds_read_b64_tr_b16 v[106:107], v18 offset:26112
    v_mfma_f32_16x16x32_bf16 v[144:147], v[52:55], v[36:39], v[144:147]
    ds_read_b64_tr_b16 v[108:109], v16 offset:36864
    ds_read_b64_tr_b16 v[110:111], v16 offset:38400
    ds_read_b64_tr_b16 v[112:113], v17 offset:36864
    v_mfma_f32_16x16x32_bf16 v[136:139], v[56:59], v[32:35], v[136:139]
    ds_read_b64_tr_b16 v[114:115], v17 offset:38400
    ds_read_b64_tr_b16 v[116:117], v18 offset:36864
    ds_read_b64_tr_b16 v[118:119], v18 offset:38400
    s_add_u32 m0, s25, 73728
    s_nop 0
    buffer_load_dwordx4 v8, s[12:15], s26 offen  lds
    v_mfma_f32_16x16x32_bf16 v[148:151], v[56:59], v[36:39], v[148:151]
    s_add_u32 m0, s25, 74752
    s_nop 0
    buffer_load_dwordx4 v9, s[12:15], s26 offen  lds
    s_add_u32 m0, s25, 75776
    s_nop 0
    buffer_load_dwordx4 v10, s[12:15], s26 offen  lds
    s_add_u32 s26, s26, 196608
    v_mfma_f32_16x16x32_bf16 v[128:131], v[60:63], v[40:43], v[128:131]
    v_lshlrev_b32 v212, 16, v188
    v_and_b32 v213, 0xffff0000, v188
    v_fma_f32 v212, v212, v208, v209
    v_mfma_f32_16x16x32_bf16 v[140:143], v[60:63], v[44:47], v[140:143]
    v_fma_f32 v213, v213, v208, v209
    v_cvt_pk_bf16_f32 v188, v212, v213
    v_lshlrev_b32 v212, 16, v189
    v_and_b32 v213, 0xffff0000, v189
    v_mfma_f32_16x16x32_bf16 v[132:135], v[64:67], v[40:43], v[132:135]
    v_fma_f32 v212, v212, v208, v209
    v_fma_f32 v213, v213, v208, v209
    v_cvt_pk_bf16_f32 v189, v212, v213
    v_mfma_f32_16x16x32_bf16 v[144:147], v[64:67], v[44:47], v[144:147]
    v_lshlrev_b32 v212, 16, v190
    v_and_b32 v213, 0xffff0000, v190
    v_fma_f32 v212, v212, v208, v209
    v_fma_f32 v213, v213, v208, v209
    v_mfma_f32_16x16x32_bf16 v[136:139], v[68:71], v[40:43], v[136:139]
    v_cvt_pk_bf16_f32 v190, v212, v213
    v_lshlrev_b32 v212, 16, v191
    v_and_b32 v213, 0xffff0000, v191
    v_mfma_f32_16x16x32_bf16 v[148:151], v[68:71], v[44:47], v[148:151]
    v_fma_f32 v212, v212, v208, v209
    v_fma_f32 v213, v213, v208, v209
    v_cvt_pk_bf16_f32 v191, v212, v213
    ds_write_b128 v211, v[188:191] offset:256
    s_waitcnt vmcnt(3) lgkmcnt(0)
    s_barrier
    v_mfma_f32_16x16x32_bf16 v[128:131], v[96:99], v[80:83], v[128:131]
    ds_read_b128 v[32:35], v24 offset:256
    ds_read_b128 v[36:39], v24 offset:16640
    ds_read_b128 v[40:43], v25 offset:256
    v_mfma_f32_16x16x32_bf16 v[140:143], v[96:99], v[84:87], v[140:143]
    ds_read_b128 v[44:47], v25 offset:16640
    ds_read_b64_tr_b16 v[48:49], v19 offset:0
    ds_read_b64_tr_b16 v[50:51], v19 offset:1536
    v_mfma_f32_16x16x32_bf16 v[132:135], v[100:103], v[80:83], v[132:135]
    ds_read_b64_tr_b16 v[52:53], v20 offset:0
    ds_read_b64_tr_b16 v[54:55], v20 offset:1536
    ds_read_b64_tr_b16 v[56:57], v21 offset:0
    ds_read_b64_tr_b16 v[58:59], v21 offset:1536
    v_mfma_f32_16x16x32_bf16 v[144:147], v[100:103], v[84:87], v[144:147]
    ds_read_b64_tr_b16 v[60:61], v19 offset:12288
    ds_read_b64_tr_b16 v[62:63], v19 offset:13824
    ds_read_b64_tr_b16 v[64:65], v20 offset:12288
    v_mfma_f32_16x16x32_bf16 v[136:139], v[104:107], v[80:83], v[136:139]
    ds_read_b64_tr_b16 v[66:67], v20 offset:13824
    ds_read_b64_tr_b16 v[68:69], v21 offset:12288
    ds_read_b64_tr_b16 v[70:71], v21 offset:13824
    s_add_u32 m0, s25, 0
    s_nop 0
    buffer_load_dwordx4 v8, s[12:15], s26 offen  lds
    v_mfma_f32_16x16x32_bf16 v[148:151], v[104:107], v[84:87], v[148:151]
    s_add_u32 m0, s25, 1024
    s_nop 0
    buffer_load_dwordx4 v9, s[12:15], s26 offen  lds
    s_add_u32 m0, s25, 2048
    s_nop 0
    buffer_load_dwordx4 v10, s[12:15], s26 offen  lds
    s_add_u32 s26, s26, 196608
    v_mfma_f32_16x16x32_bf16 v[128:131], v[108:111], v[88:91], v[128:131]
    v_lshlrev_b32 v212, 16, v192
    v_and_b32 v213, 0xffff0000, v192
    v_fma_f32 v212, v212, v208, v209
    v_mfma_f32_16x16x32_bf16 v[140:143], v[108:111], v[92:95], v[140:143]
    v_fma_f32 v213, v213, v208, v209
    v_cvt_pk_bf16_f32 v192, v212, v213
    v_lshlrev_b32 v212, 16, v193
    v_and_b32 v213, 0xffff0000, v193
    v_mfma_f32_16x16x32_bf16 v[132:135], v[112:115], v[88:91], v[132:135]
    v_fma_f32 v212, v212, v208, v209
    v_fma_f32 v213, v213, v208, v209
    v_cvt_pk_bf16_f32 v193, v212, v213
    v_mfma_f32_16x16x32_bf16 v[144:147], v[112:115], v[92:95], v[144:147]
    v_lshlrev_b32 v212, 16, v194
    v_and_b32 v213, 0xffff0000, v194
    v_fma_f32 v212, v212, v208, v209
    v_fma_f32 v213, v213, v208, v209
    v_mfma_f32_16x16x32_bf16 v[136:139], v[116:119], v[88:91], v[136:139]
    v_cvt_pk_bf16_f32 v194, v212, v213
    v_lshlrev_b32 v212, 16, v195
    v_and_b32 v213, 0xffff0000, v195
    v_mfma_f32_16x16x32_bf16 v[148:151], v[116:119], v[92:95], v[148:151]
    v_fma_f32 v212, v212, v208, v209
    v_fma_f32 v213, v213, v208, v209
    v_cvt_pk_bf16_f32 v195, v212, v213
    ds_write_b128 v210, v[192:195] offset:512
    s_waitcnt vmcnt(3) lgkmcnt(0)
    s_barrier
    v_mfma_f32_16x16x32_bf16 v[128:131], v[48:51], v[32:35], v[128:131]
    ds_read_b128 v[80:83], v26 offset:256
    ds_read_b128 v[84:87], v26 offset:16640
    ds_read_b128 v[88:91], v27 offset:256
    v_mfma_f32_16x16x32_bf16 v[140:143], v[48:51], v[36:39], v[140:143]
    ds_read_b128 v[92:95], v27 offset:16640
    ds_read_b64_tr_b16 v[96:97], v19 offset:24576
    ds_read_b64_tr_b16 v[98:99], v19 offset:26112
    v_mfma_f32_16x16x32_bf16 v[132:135], v[52:55], v[32:35], v[132:135]
    ds_read_b64_tr_b16 v[100:101], v20 offset:24576
    ds_read_b64_tr_b16 v[102:103], v20 offset:26112
    ds_read_b64_tr_b16 v[104:105], v21 offset:24576
    ds_read_b64_tr_b16 v[106:107], v21 offset:26112
    v_mfma_f32_16x16x32_bf16 v[144:147], v[52:55], v[36:39], v[144:147]
    ds_read_b64_tr_b16 v[108:109], v19 offset:36864
    ds_read_b64_tr_b16 v[110:111], v19 offset:38400
    ds_read_b64_tr_b16 v[112:113], v20 offset:36864
    v_mfma_f32_16x16x32_bf16 v[136:139], v[56:59], v[32:35], v[136:139]
    ds_read_b64_tr_b16 v[114:115], v20 offset:38400
    ds_read_b64_tr_b16 v[116:117], v21 offset:36864
    ds_read_b64_tr_b16 v[118:119], v21 offset:38400
    s_add_u32 m0, s25, 24576
    s_nop 0
    buffer_load_dwordx4 v8, s[12:15], s26 offen  lds
    v_mfma_f32_16x16x32_bf16 v[148:151], v[56:59], v[36:39], v[148:151]
    s_add_u32 m0, s25, 25600
    s_nop 0
    buffer_load_dwordx4 v9, s[12:15], s26 offen  lds
    s_add_u32 m0, s25, 26624
    s_nop 0
    buffer_load_dwordx4 v10, s[12:15], s26 offen  lds
    s_add_u32 s26, s26, 196608
    v_mfma_f32_16x16x32_bf16 v[128:131], v[60:63], v[40:43], v[128:131]
    v_lshlrev_b32 v212, 16, v196
    v_and_b32 v213, 0xffff0000, v196
    v_fma_f32 v212, v212, v208, v209
    v_mfma_f32_16x16x32_bf16 v[140:143], v[60:63], v[44:47], v[140:143]
    v_fma_f32 v213, v213, v208, v209
    v_cvt_pk_bf16_f32 v196, v212, v213
    v_lshlrev_b32 v212, 16, v197
    v_and_b32 v213, 0xffff0000, v197
    v_mfma_f32_16x16x32_bf16 v[132:135], v[64:67], v[40:43], v[132:135]
    v_fma_f32 v212, v212, v208, v209
    v_fma_f32 v213, v213, v208, v209
    v_cvt_pk_bf16_f32 v197, v212, v213
    v_mfma_f32_16x16x32_bf16 v[144:147], v[64:67], v[44:47], v[144:147]
    v_lshlrev_b32 v212, 16, v198
    v_and_b32 v213, 0xffff0000, v198
    v_fma_f32 v212, v212, v208, v209
    v_fma_f32 v213, v213, v208, v209
    v_mfma_f32_16x16x32_bf16 v[136:139], v[68:71], v[40:43], v[136:139]
    v_cvt_pk_bf16_f32 v198, v212, v213
    v_lshlrev_b32 v212, 16, v199
    v_and_b32 v213, 0xffff0000, v199
    v_mfma_f32_16x16x32_bf16 v[148:151], v[68:71], v[44:47], v[148:151]
    v_fma_f32 v212, v212, v208, v209
    v_fma_f32 v213, v213, v208, v209
    v_cvt_pk_bf16_f32 v199, v212, v213
    ds_write_b128 v211, v[196:199] offset:512
    s_waitcnt vmcnt(3) lgkmcnt(0)
    s_barrier
    v_mfma_f32_16x16x32_bf16 v[128:131], v[96:99], v[80:83], v[128:131]
    ds_read_b128 v[32:35], v24 offset:512
    ds_read_b128 v[36:39], v24 offset:16896
    ds_read_b128 v[40:43], v25 offset:512
    v_mfma_f32_16x16x32_bf16 v[140:143], v[96:99], v[84:87], v[140:143]
    ds_read_b128 v[44:47], v25 offset:16896
    ds_read_b64_tr_b16 v[48:49], v16 offset:0
    ds_read_b64_tr_b16 v[50:51], v16 offset:1536
    v_mfma_f32_16x16x32_bf16 v[132:135], v[100:103], v[80:83], v[132:135]
    ds_read_b64_tr_b16 v[52:53], v17 offset:0
    ds_read_b64_tr_b16 v[54:55], v17 offset:1536
    ds_read_b64_tr_b16 v[56:57], v18 offset:0
    ds_read_b64_tr_b16 v[58:59], v18 offset:1536
    v_mfma_f32_16x16x32_bf16 v[144:147], v[100:103], v[84:87], v[144:147]
    ds_read_b64_tr_b16 v[60:61], v16 offset:12288
    ds_read_b64_tr_b16 v[62:63], v16 offset:13824
    ds_read_b64_tr_b16 v[64:65], v17 offset:12288
    v_mfma_f32_16x16x32_bf16 v[136:139], v[104:107], v[80:83], v[136:139]
    ds_read_b64_tr_b16 v[66:67], v17 offset:13824
    ds_read_b64_tr_b16 v[68:69], v18 offset:12288
    ds_read_b64_tr_b16 v[70:71], v18 offset:13824
    s_add_u32 m0, s25, 49152
    s_nop 0
    buffer_load_dwordx4 v8, s[12:15], s26 offen  lds
    v_mfma_f32_16x16x32_bf16 v[148:151], v[104:107], v[84:87], v[148:151]
    s_add_u32 m0, s25, 50176
    s_nop 0
    buffer_load_dwordx4 v9, s[12:15], s26 offen  lds
    s_add_u32 m0, s25, 51200
    s_nop 0
    buffer_load_dwordx4 v10, s[12:15], s26 offen  lds
    s_add_u32 s26, s26, 196608
    v_mfma_f32_16x16x32_bf16 v[128:131], v[108:111], v[88:91], v[128:131]
    v_lshlrev_b32 v212, 16, v200
    v_and_b32 v213, 0xffff0000, v200
    v_fma_f32 v212, v212, v208, v209
    v_mfma_f32_16x16x32_bf16 v[140:143], v[108:111], v[92:95], v[140:143]
    v_fma_f32 v213, v213, v208, v209
    v_cvt_pk_bf16_f32 v200, v212, v213
    v_lshlrev_b32 v212, 16, v201
    v_and_b32 v213, 0xffff0000, v201
    v_mfma_f32_16x16x32_bf16 v[132:135], v[112:115], v[88:91], v[132:135]
    v_fma_f32 v212, v212, v208, v209
    v_fma_f32 v213, v213, v208, v209
    v_cvt_pk_bf16_f32 v201, v212, v213
    v_mfma_f32_16x16x32_bf16 v[144:147], v[112:115], v[92:95], v[144:147]
    v_lshlrev_b32 v212, 16, v202
    v_and_b32 v213, 0xffff0000, v202
    v_fma_f32 v212, v212, v208, v209
    v_fma_f32 v213, v213, v208, v209
    v_mfma_f32_16x16x32_bf16 v[136:139], v[116:119], v[88:91], v[136:139]
    v_cvt_pk_bf16_f32 v202, v212, v213
    v_lshlrev_b32 v212, 16, v203
    v_and_b32 v213, 0xffff0000, v203
    v_mfma_f32_16x16x32_bf16 v[148:151], v[116:119], v[92:95], v[148:151]
    v_fma_f32 v212, v212, v208, v209
    v_fma_f32 v213, v213, v208, v209
    v_cvt_pk_bf16_f32 v203, v212, v213
    ds_write_b128 v210, v[200:203] offset:768
    s_waitcnt vmcnt(3) lgkmcnt(0)
    s_barrier
    v_mfma_f32_16x16x32_bf16 v[128:131], v[48:51], v[32:35], v[128:131]
    ds_read_b128 v[80:83], v26 offset:512
    ds_read_b128 v[84:87], v26 offset:16896
    ds_read_b128 v[88:91], v27 offset:512
    v_mfma_f32_16x16x32_bf16 v[140:143], v[48:51], v[36:39], v[140:143]
    ds_read_b128 v[92:95], v27 offset:16896
    ds_read_b64_tr_b16 v[96:97], v16 offset:24576
    ds_read_b64_tr_b16 v[98:99], v16 offset:26112
    v_mfma_f32_16x16x32_bf16 v[132:135], v[52:55], v[32:35], v[132:135]
    ds_read_b64_tr_b16 v[100:101], v17 offset:24576
    ds_read_b64_tr_b16 v[102:103], v17 offset:26112
    ds_read_b64_tr_b16 v[104:105], v18 offset:24576
    ds_read_b64_tr_b16 v[106:107], v18 offset:26112
    v_mfma_f32_16x16x32_bf16 v[144:147], v[52:55], v[36:39], v[144:147]
    ds_read_b64_tr_b16 v[108:109], v16 offset:36864
    ds_read_b64_tr_b16 v[110:111], v16 offset:38400
    ds_read_b64_tr_b16 v[112:113], v17 offset:36864
    v_mfma_f32_16x16x32_bf16 v[136:139], v[56:59], v[32:35], v[136:139]
    ds_read_b64_tr_b16 v[114:115], v17 offset:38400
    ds_read_b64_tr_b16 v[116:117], v18 offset:36864
    ds_read_b64_tr_b16 v[118:119], v18 offset:38400
    s_add_u32 m0, s25, 73728
    s_nop 0
    buffer_load_dwordx4 v8, s[12:15], s26 offen  lds
    v_mfma_f32_16x16x32_bf16 v[148:151], v[56:59], v[36:39], v[148:151]
    s_add_u32 m0, s25, 74752
    s_nop 0
    buffer_load_dwordx4 v9, s[12:15], s26 offen  lds
    s_add_u32 m0, s25, 75776
    s_nop 0
    buffer_load_dwordx4 v10, s[12:15], s26 offen  lds
    s_add_u32 s26, s26, 196608
    v_mfma_f32_16x16x32_bf16 v[128:131], v[60:63], v[40:43], v[128:131]
    v_lshlrev_b32 v212, 16, v204
    v_and_b32 v213, 0xffff0000, v204
    v_fma_f32 v212, v212, v208, v209
    v_mfma_f32_16x16x32_bf16 v[140:143], v[60:63], v[44:47], v[140:143]
    v_fma_f32 v213, v213, v208, v209
    v_cvt_pk_bf16_f32 v204, v212, v213
    v_lshlrev_b32 v212, 16, v205
    v_and_b32 v213, 0xffff0000, v205
    v_mfma_f32_16x16x32_bf16 v[132:135], v[64:67], v[40:43], v[132:135]
    v_fma_f32 v212, v212, v208, v209
    v_fma_f32 v213, v213, v208, v209
    v_cvt_pk_bf16_f32 v205, v212, v213
    v_mfma_f32_16x16x32_bf16 v[144:147], v[64:67], v[44:47], v[144:147]
    v_lshlrev_b32 v212, 16, v206
    v_and_b32 v213, 0xffff0000, v206
    v_fma_f32 v212, v212, v208, v209
    v_fma_f32 v213, v213, v208, v209
    v_mfma_f32_16x16x32_bf16 v[136:139], v[68:71], v[40:43], v[136:139]
    v_cvt_pk_bf16_f32 v206, v212, v213
    v_lshlrev_b32 v212, 16, v207
    v_and_b32 v213, 0xffff0000, v207
    v_mfma_f32_16x16x32_bf16 v[148:151], v[68:71], v[44:47], v[148:151]
    v_fma_f32 v212, v212, v208, v209
    v_fma_f32 v213, v213, v208, v209
    v_cvt_pk_bf16_f32 v207, v212, v213
    ds_write_b128 v211, v[204:207] offset:768
    s_waitcnt vmcnt(3) lgkmcnt(0)
    s_barrier
    v_mfma_f32_16x16x32_bf16 v[128:131], v[96:99], v[80:83], v[128:131]
    ds_read_b128 v[32:35], v24 offset:768
    v_mfma_f32_16x16x32_bf16 v[140:143], v[96:99], v[84:87], v[140:143]
    ds_read_b128 v[36:39], v24 offset:17152
    v_mfma_f32_16x16x32_bf16 v[132:135], v[100:103], v[80:83], v[132:135]
    ds_read_b128 v[40:43], v25 offset:768
    ds_read_b128 v[44:47], v25 offset:17152
    v_mfma_f32_16x16x32_bf16 v[144:147], v[100:103], v[84:87], v[144:147]
    ds_read_b64_tr_b16 v[48:49], v19 offset:0
    v_mfma_f32_16x16x32_bf16 v[136:139], v[104:107], v[80:83], v[136:139]
    ds_read_b64_tr_b16 v[50:51], v19 offset:1536
    v_mfma_f32_16x16x32_bf16 v[148:151], v[104:107], v[84:87], v[148:151]
    ds_read_b64_tr_b16 v[52:53], v20 offset:0
    ds_read_b64_tr_b16 v[54:55], v20 offset:1536
    v_mfma_f32_16x16x32_bf16 v[128:131], v[108:111], v[88:91], v[128:131]
    ds_read_b64_tr_b16 v[56:57], v21 offset:0
    v_mfma_f32_16x16x32_bf16 v[140:143], v[108:111], v[92:95], v[140:143]
    ds_read_b64_tr_b16 v[58:59], v21 offset:1536
    v_mfma_f32_16x16x32_bf16 v[132:135], v[112:115], v[88:91], v[132:135]
    ds_read_b64_tr_b16 v[60:61], v19 offset:12288
    ds_read_b64_tr_b16 v[62:63], v19 offset:13824
    v_mfma_f32_16x16x32_bf16 v[144:147], v[112:115], v[92:95], v[144:147]
    ds_read_b64_tr_b16 v[64:65], v20 offset:12288
    v_mfma_f32_16x16x32_bf16 v[136:139], v[116:119], v[88:91], v[136:139]
    ds_read_b64_tr_b16 v[66:67], v20 offset:13824
    v_mfma_f32_16x16x32_bf16 v[148:151], v[116:119], v[92:95], v[148:151]
    ds_read_b64_tr_b16 v[68:69], v21 offset:12288
    ds_read_b64_tr_b16 v[70:71], v21 offset:13824
    s_waitcnt vmcnt(0) lgkmcnt(0)
    s_barrier
    v_mfma_f32_16x16x32_bf16 v[128:131], v[48:51], v[32:35], v[128:131]
    ds_read_b128 v[80:83], v26 offset:768
    v_mfma_f32_16x16x32_bf16 v[140:143], v[48:51], v[36:39], v[140:143]
    ds_read_b128 v[84:87], v26 offset:17152
    v_mfma_f32_16x16x32_bf16 v[132:135], v[52:55], v[32:35], v[132:135]
    ds_read_b128 v[88:91], v27 offset:768
    ds_read_b128 v[92:95], v27 offset:17152
    v_mfma_f32_16x16x32_bf16 v[144:147], v[52:55], v[36:39], v[144:147]
    ds_read_b64_tr_b16 v[96:97], v19 offset:24576
    v_mfma_f32_16x16x32_bf16 v[136:139], v[56:59], v[32:35], v[136:139]
    ds_read_b64_tr_b16 v[98:99], v19 offset:26112
    v_mfma_f32_16x16x32_bf16 v[148:151], v[56:59], v[36:39], v[148:151]
    ds_read_b64_tr_b16 v[100:101], v20 offset:24576
    ds_read_b64_tr_b16 v[102:103], v20 offset:26112
    v_mfma_f32_16x16x32_bf16 v[128:131], v[60:63], v[40:43], v[128:131]
    ds_read_b64_tr_b16 v[104:105], v21 offset:24576
    v_mfma_f32_16x16x32_bf16 v[140:143], v[60:63], v[44:47], v[140:143]
    ds_read_b64_tr_b16 v[106:107], v21 offset:26112
    v_mfma_f32_16x16x32_bf16 v[132:135], v[64:67], v[40:43], v[132:135]
    ds_read_b64_tr_b16 v[108:109], v19 offset:36864
    ds_read_b64_tr_b16 v[110:111], v19 offset:38400
    v_mfma_f32_16x16x32_bf16 v[144:147], v[64:67], v[44:47], v[144:147]
    ds_read_b64_tr_b16 v[112:113], v20 offset:36864
    v_mfma_f32_16x16x32_bf16 v[136:139], v[68:71], v[40:43], v[136:139]
    ds_read_b64_tr_b16 v[114:115], v20 offset:38400
    v_mfma_f32_16x16x32_bf16 v[148:151], v[68:71], v[44:47], v[148:151]
    ds_read_b64_tr_b16 v[116:117], v21 offset:36864
    ds_read_b64_tr_b16 v[118:119], v21 offset:38400
    s_waitcnt lgkmcnt(0)
    v_mfma_f32_16x16x32_bf16 v[128:131], v[96:99], v[80:83], v[128:131]
    v_mfma_f32_16x16x32_bf16 v[140:143], v[96:99], v[84:87], v[140:143]
    v_mfma_f32_16x16x32_bf16 v[132:135], v[100:103], v[80:83], v[132:135]
    v_mfma_f32_16x16x32_bf16 v[144:147], v[100:103], v[84:87], v[144:147]
    v_mfma_f32_16x16x32_bf16 v[136:139], v[104:107], v[80:83], v[136:139]
    v_mfma_f32_16x16x32_bf16 v[148:151], v[104:107], v[84:87], v[148:151]
    v_mfma_f32_16x16x32_bf16 v[128:131], v[108:111], v[88:91], v[128:131]
    v_mfma_f32_16x16x32_bf16 v[140:143], v[108:111], v[92:95], v[140:143]
    v_mfma_f32_16x16x32_bf16 v[132:135], v[112:115], v[88:91], v[132:135]
    v_mfma_f32_16x16x32_bf16 v[144:147], v[112:115], v[92:95], v[144:147]
    v_mfma_f32_16x16x32_bf16 v[136:139], v[116:119], v[88:91], v[136:139]
    v_mfma_f32_16x16x32_bf16 v[148:151], v[116:119], v[92:95], v[148:151]
    s_barrier
    v_lshlrev_b32 v6, 5, v4
    v_lshl_add_u32 v6, v5, 3, v6
    s_lshl_b32 s27, s20, 9
    v_add_u32 v7, s27, v6
    v_lshrrev_b32 v11, 2, v4
    v_and_b32 v12, 3, v4
    v_lshl_add_u32 v11, v5, 2, v11
    v_lshlrev_b32 v11, 5, v11
    v_lshl_add_u32 v11, v12, 3, v11
    v_add_u32 v11, s27, v11
    s_mul_i32 s29, s21, 12
    s_mul_i32 s27, s24, 3
    s_add_u32 s29, s29, s27
    s_lshl_b32 s30, s22, 2
    s_lshl_b32 s27, s23, 1
    s_add_u32 s30, s30, s27
    s_nop 4
    v_cvt_pk_bf16_f32 v32, v128, v129
    v_cvt_pk_bf16_f32 v33, v130, v131
    s_add_u32 s27, s29, 0
    s_add_u32 s28, s30, 0
    s_cmp_ge_u32 s27, 64
    s_cbranch_scc1 k_qkv_kernel_v00
    s_lshl_b32 s27, s27, 16
    s_lshl_b32 s28, s28, 9
    s_add_u32 s27, s27, s28
    buffer_store_dwordx2 v[32:33], v6, s[16:19], s27 offen
    s_branch k_qkv_kernel_n00
k_qkv_kernel_v00:
    ds_write_b64 v7, v[32:33]
    s_waitcnt lgkmcnt(0)
    ds_read_b64_tr_b16 v[34:35], v11
    s_sub_u32 s27, s27, 64
    s_lshl_b32 s27, s27, 16
    s_lshl_b32 s28, s28, 9
    s_add_u32 s27, s27, s28
    s_add_u32 s27, s27, 4194304
    s_waitcnt lgkmcnt(0)
    buffer_store_dwordx2 v[34:35], v6, s[16:19], s27 offen
k_qkv_kernel_n00:
    s_nop 1
    v_cvt_pk_bf16_f32 v32, v140, v141
    v_cvt_pk_bf16_f32 v33, v142, v143
    s_add_u32 s27, s29, 0
    s_add_u32 s28, s30, 1
    s_cmp_ge_u32 s27, 64
    s_cbranch_scc1 k_qkv_kernel_v01
    s_lshl_b32 s27, s27, 16
    s_lshl_b32 s28, s28, 9
    s_add_u32 s27, s27, s28
    buffer_store_dwordx2 v[32:33], v6, s[16:19], s27 offen
    s_branch k_qkv_kernel_n01
k_qkv_kernel_v01:
    ds_write_b64 v7, v[32:33]
    s_waitcnt lgkmcnt(0)
    ds_read_b64_tr_b16 v[34:35], v11
    s_sub_u32 s27, s27, 64
    s_lshl_b32 s27, s27, 16
    s_lshl_b32 s28, s28, 9
    s_add_u32 s27, s27, s28
    s_add_u32 s27, s27, 4194304
    s_waitcnt lgkmcnt(0)
    buffer_store_dwordx2 v[34:35], v6, s[16:19], s27 offen
k_qkv_kernel_n01:
    s_nop 1
    v_cvt_pk_bf16_f32 v32, v132, v133
    v_cvt_pk_bf16_f32 v33, v134, v135
    s_add_u32 s27, s29, 1
    s_add_u32 s28, s30, 0
    s_cmp_ge_u32 s27, 64
    s_cbranch_scc1 k_qkv_kernel_v10
    s_lshl_b32 s27, s27, 16
    s_lshl_b32 s28, s28, 9
    s_add_u32 s27, s27, s28
    buffer_store_dwordx2 v[32:33], v6, s[16:19], s27 offen
    s_branch k_qkv_kernel_n10
k_qkv_kernel_v10:
    ds_write_b64 v7, v[32:33]
    s_waitcnt lgkmcnt(0)
    ds_read_b64_tr_b16 v[34:35], v11
    s_sub_u32 s27, s27, 64
    s_lshl_b32 s27, s27, 16
    s_lshl_b32 s28, s28, 9
    s_add_u32 s27, s27, s28
    s_add_u32 s27, s27, 4194304
    s_waitcnt lgkmcnt(0)
    buffer_store_dwordx2 v[34:35], v6, s[16:19], s27 offen
k_qkv_kernel_n10:
    s_nop 1
    v_cvt_pk_bf16_f32 v32, v144, v145
    v_cvt_pk_bf16_f32 v33, v146, v147
    s_add_u32 s27, s29, 1
    s_add_u32 s28, s30, 1
    s_cmp_ge_u32 s27, 64
    s_cbranch_scc1 k_qkv_kernel_v11
    s_lshl_b32 s27, s27, 16
    s_lshl_b32 s28, s28, 9
    s_add_u32 s27, s27, s28
    buffer_store_dwordx2 v[32:33], v6, s[16:19], s27 offen
    s_branch k_qkv_kernel_n11
k_qkv_kernel_v11:
    ds_write_b64 v7, v[32:33]
    s_waitcnt lgkmcnt(0)
    ds_read_b64_tr_b16 v[34:35], v11
    s_sub_u32 s27, s27, 64
    s_lshl_b32 s27, s27, 16
    s_lshl_b32 s28, s28, 9
    s_add_u32 s27, s27, s28
    s_add_u32 s27, s27, 4194304
    s_waitcnt lgkmcnt(0)
    buffer_store_dwordx2 v[34:35], v6, s[16:19], s27 offen
k_qkv_kernel_n11:
    s_nop 1
    v_cvt_pk_bf16_f32 v32, v136, v137
    v_cvt_pk_bf16_f32 v33, v138, v139
    s_add_u32 s27, s29, 2
    s_add_u32 s28, s30, 0
    s_cmp_ge_u32 s27, 64
    s_cbranch_scc1 k_qkv_kernel_v20
    s_lshl_b32 s27, s27, 16
    s_lshl_b32 s28, s28, 9
    s_add_u32 s27, s27, s28
    buffer_store_dwordx2 v[32:33], v6, s[16:19], s27 offen
    s_branch k_qkv_kernel_n20
k_qkv_kernel_v20:
    ds_write_b64 v7, v[32:33]
    s_waitcnt lgkmcnt(0)
    ds_read_b64_tr_b16 v[34:35], v11
    s_sub_u32 s27, s27, 64
    s_lshl_b32 s27, s27, 16
    s_lshl_b32 s28, s28, 9
    s_add_u32 s27, s27, s28
    s_add_u32 s27, s27, 4194304
    s_waitcnt lgkmcnt(0)
    buffer_store_dwordx2 v[34:35], v6, s[16:19], s27 offen
k_qkv_kernel_n20:
    s_nop 1
    v_cvt_pk_bf16_f32 v32, v148, v149
    v_cvt_pk_bf16_f32 v33, v150, v151
    s_add_u32 s27, s29, 2
    s_add_u32 s28, s30, 1
    s_cmp_ge_u32 s27, 64
    s_cbranch_scc1 k_qkv_kernel_v21
    s_lshl_b32 s27, s27, 16
    s_lshl_b32 s28, s28, 9
    s_add_u32 s27, s27, s28
    buffer_store_dwordx2 v[32:33], v6, s[16:19], s27 offen
    s_branch k_qkv_kernel_n21
k_qkv_kernel_v21:
    ds_write_b64 v7, v[32:33]
    s_waitcnt lgkmcnt(0)
    ds_read_b64_tr_b16 v[34:35], v11
    s_sub_u32 s27, s27, 64
    s_lshl_b32 s27, s27, 16
    s_lshl_b32 s28, s28, 9
    s_add_u32 s27, s27, s28
    s_add_u32 s27, s27, 4194304
    s_waitcnt lgkmcnt(0)
    buffer_store_dwordx2 v[34:35], v6, s[16:19], s27 offen
k_qkv_kernel_n21:
    s_nop 1
k_qkv_kernel_done:
    s_endpgm
.text
.globl k_attn_kernel
.p2align 8
.type k_attn_kernel,@function
k_attn_kernel:
    s_cmp_ge_u32 s2, 512
    s_cbranch_scc1 k_attn_kernel_done
    s_load_dwordx2 s[40:41], s[0:1], 72
    s_load_dwordx2 s[42:43], s[0:1], 16
    s_load_dwordx4 s[44:47], s[0:1], 32
    s_load_dwordx2 s[48:49], s[0:1], 48
    v_lshrrev_b32 v1, 6, v0
    v_and_b32 v2, 63, v0
    s_nop 0
    v_readfirstlane_b32 s20, v1
    s_bfe_u32 s21, s2, 0x10002
    s_lshl_b32 s21, s21, 4
    s_lshr_b32 s23, s2, 5
    s_add_u32 s21, s21, s23
    s_and_b32 s22, s2, 3
    s_lshl_b32 s22, s22, 2
    s_bfe_u32 s23, s2, 0x20003
    s_add_u32 s22, s22, s23
    s_lshl_b32 s22, s22, 3
    v_and_b32 v4, 15, v2
    v_lshrrev_b32 v5, 4, v2
    v_lshlrev_b32 v6, 5, v4
    v_lshl_add_u32 v6, v5, 3, v6
    v_lshlrev_b32 v7, 4, v2
    s_waitcnt lgkmcnt(0)
    s_mov_b32 s8, s40
    s_mov_b32 s9, s41
    s_mov_b32 s10, 6291456
    s_mov_b32 s11, 0x00020000
    s_add_u32 s12, s40, 6291456
    s_addc_u32 s13, s41, 0
    s_mov_b32 s14, 2097152
    s_mov_b32 s15, 0x00020000
    s_lshl_b32 s23, s21, 16
    s_lshl_b32 s24, s22, 9
    s_add_u32 s24, s24, s23
    s_lshl_b32 s23, s20, 9
    s_add_u32 s23, s24, s23
    buffer_load_dwordx2 v[8:9], v6, s[8:11], s23 offen
    s_cmp_lt_u32 s20, 4
    s_mov_b32 s26, 4173824
    s_cselect_b32 s25, 2088960, s26
    s_add_u32 s25, s25, s24
    s_mul_i32 s26, s20, 3072
    s_add_u32 s25, s25, s26
    s_add_u32 m0, s26, 0
    s_nop 0
    buffer_load_dwordx4 v7, s[8:11], s25 offen lds
    s_add_u32 s25, s25, 1024
    s_add_u32 m0, s26, 1024
    s_nop 0
    buffer_load_dwordx4 v7, s[8:11], s25 offen lds
    s_add_u32 s25, s25, 1024
    s_add_u32 m0, s26, 2048
    s_nop 0
    buffer_load_dwordx4 v7, s[8:11], s25 offen lds
    s_add_u32 s22, s22, s20
    s_lshl_b32 s23, s20, 9
    v_add_u32 v10, s23, v6
    v_lshlrev_b32 v7, 2, v5
    v_sub_u32 v7, v7, v4
    v_mov_b32 v3, 0xf149f2ca
    s_cmp_lt_u32 s20, 4
    s_cbranch_scc1 k_attn_kernel_w0
    s_waitcnt vmcnt(3)
    s_branch k_attn_kernel_w1
k_attn_kernel_w0:
    s_waitcnt vmcnt(0)
k_attn_kernel_w1:
    s_barrier
    ds_read_b64 v[12:13], v10 offset:0
    ds_read_b64 v[14:15], v10 offset:512
    ds_read_b64 v[16:17], v10 offset:1024
    ds_read_b64 v[18:19], v10 offset:1536
    ds_read_b64 v[20:21], v10 offset:2048
    ds_read_b64 v[22:23], v10 offset:2560
    ds_read_b64 v[24:25], v10 offset:3072
    ds_read_b64 v[26:27], v10 offset:3584
    ds_read_b64 v[28:29], v10 offset:4096
    ds_read_b64 v[30:31], v10 offset:4608
    ds_read_b64 v[32:33], v10 offset:5120
    ds_read_b64 v[34:35], v10 offset:5632
    ds_read_b64 v[36:37], v10 offset:6144
    ds_read_b64 v[38:39], v10 offset:6656
    ds_read_b64 v[40:41], v10 offset:7168
    ds_read_b64 v[42:43], v10 offset:7680
    ds_read_b64 v[44:45], v10 offset:8192
    s_waitcnt lgkmcnt(15)
    v_mfma_f32_16x16x16_bf16 v[48:51], v[12:13], v[8:9], 0
    s_waitcnt lgkmcnt(15)
    v_mfma_f32_16x16x16_bf16 v[52:55], v[14:15], v[8:9], 0
    s_waitcnt lgkmcnt(14)
    v_mfma_f32_16x16x16_bf16 v[56:59], v[16:17], v[8:9], 0
    s_waitcnt lgkmcnt(13)
    v_mfma_f32_16x16x16_bf16 v[60:63], v[18:19], v[8:9], 0
    s_waitcnt lgkmcnt(12)
    v_mfma_f32_16x16x16_bf16 v[64:67], v[20:21], v[8:9], 0
    s_waitcnt lgkmcnt(11)
    v_mfma_f32_16x16x16_bf16 v[68:71], v[22:23], v[8:9], 0
    s_waitcnt lgkmcnt(10)
    v_mfma_f32_16x16x16_bf16 v[72:75], v[24:25], v[8:9], 0
    s_waitcnt lgkmcnt(9)
    v_mfma_f32_16x16x16_bf16 v[76:79], v[26:27], v[8:9], 0
    s_waitcnt lgkmcnt(8)
    v_mfma_f32_16x16x16_bf16 v[80:83], v[28:29], v[8:9], 0
    s_waitcnt lgkmcnt(7)
    v_mfma_f32_16x16x16_bf16 v[84:87], v[30:31], v[8:9], 0
    s_waitcnt lgkmcnt(6)
    v_mfma_f32_16x16x16_bf16 v[88:91], v[32:33], v[8:9], 0
    s_waitcnt lgkmcnt(5)
    v_mfma_f32_16x16x16_bf16 v[92:95], v[34:35], v[8:9], 0
    s_waitcnt lgkmcnt(4)
    v_mfma_f32_16x16x16_bf16 v[96:99], v[36:37], v[8:9], 0
    s_waitcnt lgkmcnt(3)
    v_mfma_f32_16x16x16_bf16 v[100:103], v[38:39], v[8:9], 0
    s_waitcnt lgkmcnt(2)
    v_mfma_f32_16x16x16_bf16 v[104:107], v[40:41], v[8:9], 0
    s_waitcnt lgkmcnt(1)
    v_mfma_f32_16x16x16_bf16 v[108:111], v[42:43], v[8:9], 0
    s_waitcnt lgkmcnt(0)
    v_mfma_f32_16x16x16_bf16 v[112:115], v[44:45], v[8:9], 0
    s_waitcnt vmcnt(0)
    s_barrier
    s_nop 4
    ds_read_b64 v[12:13], v10 offset:12288
    ds_read_b64 v[14:15], v10 offset:12800
    ds_read_b64 v[16:17], v10 offset:13312
    ds_read_b64 v[18:19], v10 offset:13824
    ds_read_b64 v[20:21], v10 offset:14336
    ds_read_b64 v[22:23], v10 offset:14848
    ds_read_b64 v[24:25], v10 offset:15360
    ds_read_b64 v[26:27], v10 offset:15872
    ds_read_b64 v[28:29], v10 offset:16384
    ds_read_b64 v[30:31], v10 offset:16896
    ds_read_b64 v[32:33], v10 offset:17408
    ds_read_b64 v[34:35], v10 offset:17920
    ds_read_b64 v[36:37], v10 offset:18432
    ds_read_b64 v[38:39], v10 offset:18944
    ds_read_b64 v[40:41], v10 offset:19456
    ds_read_b64 v[42:43], v10 offset:19968
    ds_read_b64 v[44:45], v10 offset:20480
    s_lshr_b32 s50, s2, 3
    s_lshl_b32 s50, s50, 3
    s_add_u32 s50, s50, s20
    s_bfe_u32 s51, s2, 0x10002
    s_lshl_b32 m0, s20, 10
    s_cmp_lt_u32 s50, 256
    s_cselect_b32 s56, s44, s46
    s_cselect_b32 s57, s45, s47
    s_mov_b32 s58, 1409024
    s_mov_b32 s59, 0x00020000
    s_and_b32 s68, s50, 255
    s_mul_i32 s68, s68, 5504
    s_mul_i32 s69, s51, 1536
    s_add_u32 s68, s68, s69
    v_lshrrev_b32 v1, 5, v2
    v_mul_u32_u24 v1, 2752, v1
    v_and_b32 v3, 31, v2
    v_mul_u32_u24 v3, 48, v3
    v_add_u32 v1, v1, v3
    buffer_load_dword v1, s[56:59], s68 offen lds
    s_cmp_lt_u32 s50, 172
    s_cselect_b32 s60, s48, s42
    s_cselect_b32 s61, s49, s43
    s_mov_b32 s63, 524288
    s_cselect_b32 s62, 1409024, s63
    s_mov_b32 s63, 0x00020000
    s_cselect_b32 s69, 0, 172
    s_sub_u32 s68, s50, s69
    s_lshl_b32 s68, s68, 13
    s_lshl_b32 s69, s51, 9
    s_add_u32 s68, s68, s69
    v_lshrrev_b32 v1, 3, v2
    v_lshlrev_b32 v1, 10, v1
    v_and_b32 v3, 7, v2
    v_lshl_add_u32 v1, v3, 6, v1
    v_mov_b32 v3, 0xf149f2ca
    s_cmp_ge_u32 s50, 236
    s_cbranch_scc1 k_attn_kernel_nopf
    buffer_load_dword v1, s[60:63], s68 offen lds
k_attn_kernel_nopf:
    v_add_u32 v1, 0, v7
    v_cmp_lt_i32 vcc, 0, v1
    s_nop 1
    v_cndmask_b32 v48, v3, v48, vcc
    v_cndmask_b32 v112, v112, v3, vcc
    v_add_u32 v1, 1, v7
    v_cmp_lt_i32 vcc, 0, v1
    s_nop 1
    v_cndmask_b32 v49, v3, v49, vcc
    v_cndmask_b32 v113, v113, v3, vcc
    v_add_u32 v1, 2, v7
    v_cmp_lt_i32 vcc, 0, v1
    s_nop 1
    v_cndmask_b32 v50, v3, v50, vcc
    v_cndmask_b32 v114, v114, v3, vcc
    v_add_u32 v1, 3, v7
    v_cmp_lt_i32 vcc, 0, v1
    s_nop 1
    v_cndmask_b32 v51, v3, v51, vcc
    v_cndmask_b32 v115, v115, v3, vcc
    s_cmp_ge_u32 s22, 16
    s_cbranch_scc1 k_attn_kernel_m0
    v_mov_b32 v48, v3
    v_mov_b32 v49, v3
    v_mov_b32 v50, v3
    v_mov_b32 v51, v3
k_attn_kernel_m0:
    s_cmp_ge_u32 s22, 15
    s_cbranch_scc1 k_attn_kernel_m1
    v_mov_b32 v52, v3
    v_mov_b32 v53, v3
    v_mov_b32 v54, v3
    v_mov_b32 v55, v3
k_attn_kernel_m1:
    s_cmp_ge_u32 s22, 14
    s_cbranch_scc1 k_attn_kernel_m2
    v_mov_b32 v56, v3
    v_mov_b32 v57, v3
    v_mov_b32 v58, v3
    v_mov_b32 v59, v3
k_attn_kernel_m2:
    s_cmp_ge_u32 s22, 13
    s_cbranch_scc1 k_attn_kernel_m3
    v_mov_b32 v60, v3
    v_mov_b32 v61, v3
    v_mov_b32 v62, v3
    v_mov_b32 v63, v3
k_attn_kernel_m3:
    s_cmp_ge_u32 s22, 12
    s_cbranch_scc1 k_attn_kernel_m4
    v_mov_b32 v64, v3
    v_mov_b32 v65, v3
    v_mov_b32 v66, v3
    v_mov_b32 v67, v3
k_attn_kernel_m4:
    s_cmp_ge_u32 s22, 11
    s_cbranch_scc1 k_attn_kernel_m5
    v_mov_b32 v68, v3
    v_mov_b32 v69, v3
    v_mov_b32 v70, v3
    v_mov_b32 v71, v3
k_attn_kernel_m5:
    s_cmp_ge_u32 s22, 10
    s_cbranch_scc1 k_attn_kernel_m6
    v_mov_b32 v72, v3
    v_mov_b32 v73, v3
    v_mov_b32 v74, v3
    v_mov_b32 v75, v3
k_attn_kernel_m6:
    s_cmp_ge_u32 s22, 9
    s_cbranch_scc1 k_attn_kernel_m7
    v_mov_b32 v76, v3
    v_mov_b32 v77, v3
    v_mov_b32 v78, v3
    v_mov_b32 v79, v3
k_attn_kernel_m7:
    s_cmp_ge_u32 s22, 8
    s_cbranch_scc1 k_attn_kernel_m8
    v_mov_b32 v80, v3
    v_mov_b32 v81, v3
    v_mov_b32 v82, v3
    v_mov_b32 v83, v3
k_attn_kernel_m8:
    s_cmp_ge_u32 s22, 7
    s_cbranch_scc1 k_attn_kernel_m9
    v_mov_b32 v84, v3
    v_mov_b32 v85, v3
    v_mov_b32 v86, v3
    v_mov_b32 v87, v3
k_attn_kernel_m9:
    s_cmp_ge_u32 s22, 6
    s_cbranch_scc1 k_attn_kernel_m10
    v_mov_b32 v88, v3
    v_mov_b32 v89, v3
    v_mov_b32 v90, v3
    v_mov_b32 v91, v3
k_attn_kernel_m10:
    s_cmp_ge_u32 s22, 5
    s_cbranch_scc1 k_attn_kernel_m11
    v_mov_b32 v92, v3
    v_mov_b32 v93, v3
    v_mov_b32 v94, v3
    v_mov_b32 v95, v3
k_attn_kernel_m11:
    s_cmp_ge_u32 s22, 4
    s_cbranch_scc1 k_attn_kernel_m12
    v_mov_b32 v96, v3
    v_mov_b32 v97, v3
    v_mov_b32 v98, v3
    v_mov_b32 v99, v3
k_attn_kernel_m12:
    s_cmp_ge_u32 s22, 3
    s_cbranch_scc1 k_attn_kernel_m13
    v_mov_b32 v100, v3
    v_mov_b32 v101, v3
    v_mov_b32 v102, v3
    v_mov_b32 v103, v3
k_attn_kernel_m13:
    s_cmp_ge_u32 s22, 2
    s_cbranch_scc1 k_attn_kernel_m14
    v_mov_b32 v104, v3
    v_mov_b32 v105, v3
    v_mov_b32 v106, v3
    v_mov_b32 v107, v3
k_attn_kernel_m14:
    s_cmp_ge_u32 s22, 1
    s_cbranch_scc1 k_attn_kernel_m15
    v_mov_b32 v108, v3
    v_mov_b32 v109, v3
    v_mov_b32 v110, v3
    v_mov_b32 v111, v3
k_attn_kernel_m15:
    v_max3_f32 v116, v48, v49, v50
    v_max3_f32 v117, v51, v52, v53
    v_max3_f32 v116, v116, v54, v55
    v_max3_f32 v117, v117, v56, v57
    v_max3_f32 v116, v116, v58, v59
    v_max3_f32 v117, v117, v60, v61
    v_max3_f32 v116, v116, v62, v63
    v_max3_f32 v117, v117, v64, v65
    v_max3_f32 v116, v116, v66, v67
    v_max3_f32 v117, v117, v68, v69
    v_max3_f32 v116, v116, v70, v71
    v_max3_f32 v117, v117, v72, v73
    v_max3_f32 v116, v116, v74, v75
    v_max3_f32 v117, v117, v76, v77
    v_max3_f32 v116, v116, v78, v79
    v_max3_f32 v117, v117, v80, v81
    v_max3_f32 v116, v116, v82, v83
    v_max3_f32 v117, v117, v84, v85
    v_max3_f32 v116, v116, v86, v87
    v_max3_f32 v117, v117, v88, v89
    v_max3_f32 v116, v116, v90, v91
    v_max3_f32 v117, v117, v92, v93
    v_max3_f32 v116, v116, v94, v95
    v_max3_f32 v117, v117, v96, v97
    v_max3_f32 v116, v116, v98, v99
    v_max3_f32 v117, v117, v100, v101
    v_max3_f32 v116, v116, v102, v103
    v_max3_f32 v117, v117, v104, v105
    v_max3_f32 v116, v116, v106, v107
    v_max3_f32 v117, v117, v108, v109
    v_max3_f32 v116, v116, v110, v111
    v_max3_f32 v117, v117, v112, v113
    v_max3_f32 v116, v116, v114, v115
    v_max_f32 v116, v116, v117
    v_xor_b32 v118, 16, v2
    v_lshlrev_b32 v118, 2, v118
    v_xor_b32 v119, 32, v2
    v_lshlrev_b32 v119, 2, v119
    ds_bpermute_b32 v117, v118, v116
    s_waitcnt lgkmcnt(0)
    v_max_f32 v116, v116, v117
    ds_bpermute_b32 v117, v119, v116
    s_waitcnt lgkmcnt(0)
    v_max_f32 v116, v116, v117
    s_mov_b32 s30, 0x3eb8aa3b
    v_mul_f32 v116, s30, v116
    v_sub_f32 v116, 0, v116
    v_mov_b32 v120, s30
    v_fma_f32 v48, v48, v120, v116
    v_fma_f32 v49, v49, v120, v116
    v_fma_f32 v50, v50, v120, v116
    v_fma_f32 v51, v51, v120, v116
    v_fma_f32 v52, v52, v120, v116
    v_fma_f32 v53, v53, v120, v116
    v_fma_f32 v54, v54, v120, v116
    v_fma_f32 v55, v55, v120, v116
    v_fma_f32 v56, v56, v120, v116
    v_fma_f32 v57, v57, v120, v116
    v_fma_f32 v58, v58, v120, v116
    v_fma_f32 v59, v59, v120, v116
    v_fma_f32 v60, v60, v120, v116
    v_fma_f32 v61, v61, v120, v116
    v_fma_f32 v62, v62, v120, v116
    v_fma_f32 v63, v63, v120, v116
    v_fma_f32 v64, v64, v120, v116
    v_fma_f32 v65, v65, v120, v116
    v_fma_f32 v66, v66, v120, v116
    v_fma_f32 v67, v67, v120, v116
    v_fma_f32 v68, v68, v120, v116
    v_fma_f32 v69, v69, v120, v116
    v_fma_f32 v70, v70, v120, v116
    v_fma_f32 v71, v71, v120, v116
    v_fma_f32 v72, v72, v120, v116
    v_fma_f32 v73, v73, v120, v116
    v_fma_f32 v74, v74, v120, v116
    v_fma_f32 v75, v75, v120, v116
    v_fma_f32 v76, v76, v120, v116
    v_fma_f32 v77, v77, v120, v116
    v_fma_f32 v78, v78, v120, v116
    v_fma_f32 v79, v79, v120, v116
    v_fma_f32 v80, v80, v120, v116
    v_fma_f32 v81, v81, v120, v116
    v_fma_f32 v82, v82, v120, v116
    v_fma_f32 v83, v83, v120, v116
    v_fma_f32 v84, v84, v120, v116
    v_fma_f32 v85, v85, v120, v116
    v_fma_f32 v86, v86, v120, v116
    v_fma_f32 v87, v87, v120, v116
    v_fma_f32 v88, v88, v120, v116
    v_fma_f32 v89, v89, v120, v116
    v_fma_f32 v90, v90, v120, v116
    v_fma_f32 v91, v91, v120, v116
    v_fma_f32 v92, v92, v120, v116
    v_fma_f32 v93, v93, v120, v116
    v_fma_f32 v94, v94, v120, v116
    v_fma_f32 v95, v95, v120, v116
    v_fma_f32 v96, v96, v120, v116
    v_fma_f32 v97, v97, v120, v116
    v_fma_f32 v98, v98, v120, v116
    v_fma_f32 v99, v99, v120, v116
    v_fma_f32 v100, v100, v120, v116
    v_fma_f32 v101, v101, v120, v116
    v_fma_f32 v102, v102, v120, v116
    v_fma_f32 v103, v103, v120, v116
    v_fma_f32 v104, v104, v120, v116
    v_fma_f32 v105, v105, v120, v116
    v_fma_f32 v106, v106, v120, v116
    v_fma_f32 v107, v107, v120, v116
    v_fma_f32 v108, v108, v120, v116
    v_fma_f32 v109, v109, v120, v116
    v_fma_f32 v110, v110, v120, v116
    v_fma_f32 v111, v111, v120, v116
    v_fma_f32 v112, v112, v120, v116
    v_fma_f32 v113, v113, v120, v116
    v_fma_f32 v114, v114, v120, v116
    v_fma_f32 v115, v115, v120, v116
    v_exp_f32 v48, v48
    v_exp_f32 v49, v49
    v_exp_f32 v50, v50
    v_exp_f32 v51, v51
    v_exp_f32 v52, v52
    v_exp_f32 v53, v53
    v_exp_f32 v54, v54
    v_exp_f32 v55, v55
    v_exp_f32 v56, v56
    v_exp_f32 v57, v57
    v_exp_f32 v58, v58
    v_exp_f32 v59, v59
    v_exp_f32 v60, v60
    v_exp_f32 v61, v61
    v_exp_f32 v62, v62
    v_exp_f32 v63, v63
    v_exp_f32 v64, v64
    v_exp_f32 v65, v65
    v_exp_f32 v66, v66
    v_exp_f32 v67, v67
    v_exp_f32 v68, v68
    v_exp_f32 v69, v69
    v_exp_f32 v70, v70
    v_exp_f32 v71, v71
    v_exp_f32 v72, v72
    v_exp_f32 v73, v73
    v_exp_f32 v74, v74
    v_exp_f32 v75, v75
    v_exp_f32 v76, v76
    v_exp_f32 v77, v77
    v_exp_f32 v78, v78
    v_exp_f32 v79, v79
    v_exp_f32 v80, v80
    v_exp_f32 v81, v81
    v_exp_f32 v82, v82
    v_exp_f32 v83, v83
    v_exp_f32 v84, v84
    v_exp_f32 v85, v85
    v_exp_f32 v86, v86
    v_exp_f32 v87, v87
    v_exp_f32 v88, v88
    v_exp_f32 v89, v89
    v_exp_f32 v90, v90
    v_exp_f32 v91, v91
    v_exp_f32 v92, v92
    v_exp_f32 v93, v93
    v_exp_f32 v94, v94
    v_exp_f32 v95, v95
    v_exp_f32 v96, v96
    v_exp_f32 v97, v97
    v_exp_f32 v98, v98
    v_exp_f32 v99, v99
    v_exp_f32 v100, v100
    v_exp_f32 v101, v101
    v_exp_f32 v102, v102
    v_exp_f32 v103, v103
    v_exp_f32 v104, v104
    v_exp_f32 v105, v105
    v_exp_f32 v106, v106
    v_exp_f32 v107, v107
    v_exp_f32 v108, v108
    v_exp_f32 v109, v109
    v_exp_f32 v110, v110
    v_exp_f32 v111, v111
    v_exp_f32 v112, v112
    v_exp_f32 v113, v113
    v_exp_f32 v114, v114
    v_exp_f32 v115, v115
    s_nop 0
    v_pk_add_f32 v[122:123], v[48:49], v[50:51]
    v_pk_add_f32 v[124:125], v[52:53], v[54:55]
    v_pk_add_f32 v[122:123], v[122:123], v[56:57]
    v_pk_add_f32 v[124:125], v[124:125], v[58:59]
    v_pk_add_f32 v[122:123], v[122:123], v[60:61]
    v_pk_add_f32 v[124:125], v[124:125], v[62:63]
    v_pk_add_f32 v[122:123], v[122:123], v[64:65]
    v_pk_add_f32 v[124:125], v[124:125], v[66:67]
    v_pk_add_f32 v[122:123], v[122:123], v[68:69]
    v_pk_add_f32 v[124:125], v[124:125], v[70:71]
    v_pk_add_f32 v[122:123], v[122:123], v[72:73]
    v_pk_add_f32 v[124:125], v[124:125], v[74:75]
    v_pk_add_f32 v[122:123], v[122:123], v[76:77]
    v_pk_add_f32 v[124:125], v[124:125], v[78:79]
    v_pk_add_f32 v[122:123], v[122:123], v[80:81]
    v_pk_add_f32 v[124:125], v[124:125], v[82:83]
    v_pk_add_f32 v[122:123], v[122:123], v[84:85]
    v_pk_add_f32 v[124:125], v[124:125], v[86:87]
    v_pk_add_f32 v[122:123], v[122:123], v[88:89]
    v_pk_add_f32 v[124:125], v[124:125], v[90:91]
    v_pk_add_f32 v[122:123], v[122:123], v[92:93]
    v_pk_add_f32 v[124:125], v[124:125], v[94:95]
    v_pk_add_f32 v[122:123], v[122:123], v[96:97]
    v_pk_add_f32 v[124:125], v[124:125], v[98:99]
    v_pk_add_f32 v[122:123], v[122:123], v[100:101]
    v_pk_add_f32 v[124:125], v[124:125], v[102:103]
    v_pk_add_f32 v[122:123], v[122:123], v[104:105]
    v_pk_add_f32 v[124:125], v[124:125], v[106:107]
    v_pk_add_f32 v[122:123], v[122:123], v[108:109]
    v_pk_add_f32 v[124:125], v[124:125], v[110:111]
    v_pk_add_f32 v[122:123], v[122:123], v[112:113]
    v_pk_add_f32 v[124:125], v[124:125], v[114:115]
    v_pk_add_f32 v[122:123], v[122:123], v[124:125]
    v_add_f32 v122, v122, v123
    v_cvt_pk_bf16_f32 v48, v48, v49
    v_cvt_pk_bf16_f32 v49, v50, v51
    v_cvt_pk_bf16_f32 v50, v52, v53
    v_cvt_pk_bf16_f32 v51, v54, v55
    v_cvt_pk_bf16_f32 v56, v56, v57
    v_cvt_pk_bf16_f32 v57, v58, v59
    v_cvt_pk_bf16_f32 v58, v60, v61
    v_cvt_pk_bf16_f32 v59, v62, v63
    v_cvt_pk_bf16_f32 v64, v64, v65
    v_cvt_pk_bf16_f32 v65, v66, v67
    v_cvt_pk_bf16_f32 v66, v68, v69
    v_cvt_pk_bf16_f32 v67, v70, v71
    v_cvt_pk_bf16_f32 v72, v72, v73
    v_cvt_pk_bf16_f32 v73, v74, v75
    v_cvt_pk_bf16_f32 v74, v76, v77
    v_cvt_pk_bf16_f32 v75, v78, v79
    v_cvt_pk_bf16_f32 v80, v80, v81
    v_cvt_pk_bf16_f32 v81, v82, v83
    v_cvt_pk_bf16_f32 v82, v84, v85
    v_cvt_pk_bf16_f32 v83, v86, v87
    v_cvt_pk_bf16_f32 v88, v88, v89
    v_cvt_pk_bf16_f32 v89, v90, v91
    v_cvt_pk_bf16_f32 v90, v92, v93
    v_cvt_pk_bf16_f32 v91, v94, v95
    v_cvt_pk_bf16_f32 v96, v96, v97
    v_cvt_pk_bf16_f32 v97, v98, v99
    v_cvt_pk_bf16_f32 v98, v100, v101
    v_cvt_pk_bf16_f32 v99, v102, v103
    v_cvt_pk_bf16_f32 v104, v104, v105
    v_cvt_pk_bf16_f32 v105, v106, v107
    v_cvt_pk_bf16_f32 v106, v108, v109
    v_cvt_pk_bf16_f32 v107, v110, v111
    v_cvt_pk_bf16_f32 v112, v112, v113
    v_cvt_pk_bf16_f32 v113, v114, v115
    ds_bpermute_b32 v123, v118, v122
    s_waitcnt lgkmcnt(0)
    v_add_f32 v122, v122, v123
    ds_bpermute_b32 v123, v119, v122
    s_waitcnt lgkmcnt(0)
    v_add_f32 v122, v122, v123
    v_rcp_f32 v116, v122
    v_mfma_f32_16x16x16_bf16 v[120:123], v[44:45], v[112:113], 0
    v_mfma_f32_16x16x32_bf16 v[124:127], v[12:15], v[48:51], 0
    s_nop 7
    v_mfma_f32_16x16x32_bf16 v[120:123], v[16:19], v[56:59], v[120:123]
    v_mfma_f32_16x16x32_bf16 v[124:127], v[20:23], v[64:67], v[124:127]
    v_mfma_f32_16x16x32_bf16 v[120:123], v[24:27], v[72:75], v[120:123]
    v_mfma_f32_16x16x32_bf16 v[124:127], v[28:31], v[80:83], v[124:127]
    v_mfma_f32_16x16x32_bf16 v[120:123], v[32:35], v[88:91], v[120:123]
    v_mfma_f32_16x16x32_bf16 v[124:127], v[36:39], v[96:99], v[124:127]
    v_mfma_f32_16x16x32_bf16 v[120:123], v[40:43], v[104:107], v[120:123]
    s_nop 7
    s_nop 1
    v_add_f32 v120, v120, v124
    v_add_f32 v121, v121, v125
    v_add_f32 v122, v122, v126
    v_add_f32 v123, v123, v127
    v_mul_f32 v120, v120, v116
    v_mul_f32 v121, v121, v116
    v_mul_f32 v122, v122, v116
    v_mul_f32 v123, v123, v116
    v_cvt_pk_bf16_f32 v120, v120, v121
    v_cvt_pk_bf16_f32 v121, v122, v123
    v_lshlrev_b32 v7, 10, v4
    v_lshl_add_u32 v7, v5, 3, v7
    s_lshl_b32 s23, s22, 14
    s_lshl_b32 s24, s21, 5
    s_add_u32 s23, s23, s24
    buffer_store_dwordx2 v[120:121], v7, s[12:15], s23 offen
    s_waitcnt vmcnt(0)
k_attn_kernel_done:
    s_endpgm
.text
.globl k_wo_kernel
.p2align 8
.type k_wo_kernel,@function
k_wo_kernel:
    s_cmp_ge_u32 s2, 256
    s_cbranch_scc1 k_wo_kernel_done
    s_load_dwordx2 s[32:33], s[0:1], 0
    s_load_dwordx2 s[34:35], s[0:1], 16
    s_load_dwordx2 s[36:37], s[0:1], 56
    s_load_dwordx2 s[40:41], s[0:1], 72
    v_lshrrev_b32 v1, 6, v0
    v_and_b32 v2, 63, v0
    s_nop 0
    v_readfirstlane_b32 s20, v1
    s_and_b32 s22, s2, 3
    s_lshl_b32 s22, s22, 3
    s_bfe_u32 s21, s2, 0x30003
    s_add_u32 s22, s22, s21
    s_bfe_u32 s21, s2, 0x10002
    s_lshl_b32 s21, s21, 2
    s_lshr_b32 s100, s2, 6
    s_add_u32 s21, s21, s100
    s_lshr_b32 s23, s20, 2
    s_and_b32 s24, s20, 3
    s_waitcnt lgkmcnt(0)
    s_add_u32 s8, s40, 6291456
    s_addc_u32 s9, s41, 0
    s_mov_b32 s10, 2097152
    s_mov_b32 s11, 0x00020000
    s_mov_b32 s12, s34
    s_mov_b32 s13, s35
    s_mov_b32 s14, 524288
    s_mov_b32 s15, 0x00020000
    s_mov_b32 s16, s32
    s_mov_b32 s17, s33
    s_mov_b32 s18, 2097152
    s_mov_b32 s19, 0x00020000
    s_add_u32 s44, s40, 8388608
    s_addc_u32 s45, s41, 0
    s_mov_b32 s46, 2097152
    s_mov_b32 s47, 0x00020000
    s_lshl_b32 s28, s20, 7
    v_add_u32 v12, s28, v2
    v_lshrrev_b32 v13, 4, v12
    v_and_b32 v14, 15, v12
    v_and_b32 v15, 15, v13
    v_xor_b32 v14, v14, v15
    s_mov_b32 s28, 1024
    v_mul_lo_u32 v13, v13, s28
    v_lshl_add_u32 v8, v14, 4, v13
    v_lshrrev_b32 v13, 3, v12
    v_and_b32 v14, 7, v12
    v_bfe_u32 v15, v13, 1, 1
    v_bfe_u32 v16, v13, 3, 1
    v_lshl_or_b32 v15, v16, 1, v15
    v_lshlrev_b32 v15, 1, v15
    v_xor_b32 v14, v14, v15
    v_lshlrev_b32 v13, 10, v13
    v_lshl_add_u32 v10, v14, 4, v13
    s_lshl_b32 s28, s20, 7
    v_add_u32 v12, s28, v2
    v_add_u32 v12, 64, v12
    v_lshrrev_b32 v13, 4, v12
    v_and_b32 v14, 15, v12
    v_and_b32 v15, 15, v13
    v_xor_b32 v14, v14, v15
    s_mov_b32 s28, 1024
    v_mul_lo_u32 v13, v13, s28
    v_lshl_add_u32 v9, v14, 4, v13
    v_lshrrev_b32 v13, 3, v12
    v_and_b32 v14, 7, v12
    v_bfe_u32 v15, v13, 1, 1
    v_bfe_u32 v16, v13, 3, 1
    v_lshl_or_b32 v15, v16, 1, v15
    v_lshlrev_b32 v15, 1, v15
    v_xor_b32 v14, v14, v15
    v_lshlrev_b32 v13, 10, v13
    v_lshl_add_u32 v11, v14, 4, v13
    s_mul_i32 s26, s22, 65536
    s_lshl_b32 s27, s21, 7
    s_lshl_b32 s25, s20, 11
    s_add_u32 m0, s25, 0
    s_nop 0
    buffer_load_dwordx4 v8, s[8:11], s26 offen  lds
    s_add_u32 m0, s25, 16384
    s_nop 0
    buffer_load_dwordx4 v10, s[12:15], s27 offen  lds
    s_add_u32 m0, s25, 1024
    s_nop 0
    buffer_load_dwordx4 v9, s[8:11], s26 offen  lds
    s_add_u32 m0, s25, 17408
    s_nop 0
    buffer_load_dwordx4 v11, s[12:15], s27 offen  lds
    s_add_u32 s26, s26, 256
    s_add_u32 s27, s27, 131072
    s_add_u32 m0, s25, 32768
    s_nop 0
    buffer_load_dwordx4 v8, s[8:11], s26 offen  lds
    s_add_u32 m0, s25, 49152
    s_nop 0
    buffer_load_dwordx4 v10, s[12:15], s27 offen  lds
    s_add_u32 m0, s25, 33792
    s_nop 0
    buffer_load_dwordx4 v9, s[8:11], s26 offen  lds
    s_add_u32 m0, s25, 50176
    s_nop 0
    buffer_load_dwordx4 v11, s[12:15], s27 offen  lds
    s_add_u32 s26, s26, 256
    s_add_u32 s27, s27, 131072
    v_and_b32 v4, 15, v2
    v_lshrrev_b32 v5, 4, v2
    v_lshl_add_u32 v140, v2, 4, s25
    v_add_u32 v141, 65536, v140
    s_lshl_b32 s28, s22, 6
    s_lshl_b32 s29, s23, 5
    s_add_u32 s28, s28, s29
    v_add_u32 v6, s28, v4
    v_lshlrev_b32 v6, 10, v6
    v_lshl_add_u32 v6, v5, 3, v6
    s_lshl_b32 s28, s21, 7
    s_lshl_b32 s29, s24, 5
    s_add_u32 s30, s28, s29
    v_add_u32 v7, 16384, v6
    buffer_load_dwordx2 v[136:137], v6, s[16:19], s30 offen
    buffer_load_dwordx2 v[138:139], v7, s[16:19], s30 offen
    s_lshl_b32 s28, s23, 13
    v_lshlrev_b32 v12, 8, v4
    v_add_u32 v12, s28, v12
    v_and_b32 v13, 3, v4
    v_xor_b32 v13, v13, v5
    v_lshrrev_b32 v14, 2, v4
    v_xor_b32 v15, 0, v14
    v_lshl_or_b32 v15, v15, 2, v13
    v_lshl_add_u32 v16, v15, 4, v12
    v_add_u32 v20, 65536, v16
    v_xor_b32 v15, 1, v14
    v_lshl_or_b32 v15, v15, 2, v13
    v_lshl_add_u32 v17, v15, 4, v12
    v_add_u32 v21, 65536, v17
    v_xor_b32 v15, 2, v14
    v_lshl_or_b32 v15, v15, 2, v13
    v_lshl_add_u32 v18, v15, 4, v12
    v_add_u32 v22, 65536, v18
    v_xor_b32 v15, 3, v14
    v_lshl_or_b32 v15, v15, 2, v13
    v_lshl_add_u32 v19, v15, 4, v12
    v_add_u32 v23, 65536, v19
    v_lshrrev_b32 v12, 2, v4
    v_and_b32 v13, 3, v4
    v_lshl_add_u32 v14, v5, 3, v12
    v_lshlrev_b32 v14, 7, v14
    v_lshl_add_u32 v14, v13, 3, v14
    v_lshrrev_b32 v15, 1, v12
    v_and_b32 v13, 1, v5
    v_lshl_or_b32 v15, v13, 1, v15
    v_xor_b32 v15, s24, v15
    v_lshl_add_u32 v24, v15, 5, v14
    v_add_u32 v24, 16384, v24
    v_add_u32 v25, 65536, v24
    v_mov_b32 v128, 0
    v_mov_b32 v129, 0
    v_mov_b32 v130, 0
    v_mov_b32 v131, 0
    v_mov_b32 v132, 0
    v_mov_b32 v133, 0
    v_mov_b32 v134, 0
    v_mov_b32 v135, 0
    s_waitcnt vmcnt(6) lgkmcnt(0)
    s_barrier
    ds_read_b128 v[28:31], v16 offset:0
    ds_read_b128 v[32:35], v16 offset:4096
    ds_read_b64_tr_b16 v[60:61], v24 offset:0
    ds_read_b64_tr_b16 v[62:63], v24 offset:512
    ds_read_b128 v[36:39], v17 offset:0
    ds_read_b128 v[40:43], v17 offset:4096
    ds_read_b64_tr_b16 v[64:65], v24 offset:4096
    ds_read_b64_tr_b16 v[66:67], v24 offset:4608
    ds_read_b128 v[44:47], v18 offset:0
    ds_read_b128 v[48:51], v18 offset:4096
    ds_read_b64_tr_b16 v[68:69], v24 offset:8192
    ds_read_b64_tr_b16 v[70:71], v24 offset:8704
    ds_read_b128 v[52:55], v19 offset:0
    ds_read_b128 v[56:59], v19 offset:4096
    ds_read_b64_tr_b16 v[72:73], v24 offset:12288
    ds_read_b64_tr_b16 v[74:75], v24 offset:12800
    s_add_u32 m0, s25, 65536
    s_nop 0
    buffer_load_dwordx4 v8, s[8:11], s26 offen  lds
    s_add_u32 m0, s25, 81920
    s_nop 0
    buffer_load_dwordx4 v10, s[12:15], s27 offen  lds
    s_add_u32 m0, s25, 66560
    s_nop 0
    buffer_load_dwordx4 v9, s[8:11], s26 offen  lds
    s_add_u32 m0, s25, 82944
    s_nop 0
    buffer_load_dwordx4 v11, s[12:15], s27 offen  lds
    s_add_u32 s26, s26, 256
    s_add_u32 s27, s27, 131072
    s_waitcnt vmcnt(6) lgkmcnt(0)
    s_barrier
    v_mfma_f32_16x16x32_bf16 v[128:131], v[60:63], v[28:31], v[128:131]
    ds_read_b128 v[76:79], v16 offset:32768
    ds_read_b128 v[80:83], v16 offset:36864
    v_mfma_f32_16x16x32_bf16 v[132:135], v[60:63], v[32:35], v[132:135]
    ds_read_b64_tr_b16 v[108:109], v24 offset:32768
    ds_read_b64_tr_b16 v[110:111], v24 offset:33280
    ds_read_b128 v[84:87], v17 offset:32768
    v_mfma_f32_16x16x32_bf16 v[128:131], v[64:67], v[36:39], v[128:131]
    ds_read_b128 v[88:91], v17 offset:36864
    ds_read_b64_tr_b16 v[112:113], v24 offset:36864
    ds_read_b64_tr_b16 v[114:115], v24 offset:37376
    v_mfma_f32_16x16x32_bf16 v[132:135], v[64:67], v[40:43], v[132:135]
    ds_read_b128 v[92:95], v18 offset:32768
    ds_read_b128 v[96:99], v18 offset:36864
    ds_read_b64_tr_b16 v[116:117], v24 offset:40960
    v_mfma_f32_16x16x32_bf16 v[128:131], v[68:71], v[44:47], v[128:131]
    ds_read_b64_tr_b16 v[118:119], v24 offset:41472
    ds_read_b128 v[100:103], v19 offset:32768
    v_mfma_f32_16x16x32_bf16 v[132:135], v[68:71], v[48:51], v[132:135]
    ds_read_b128 v[104:107], v19 offset:36864
    ds_read_b64_tr_b16 v[120:121], v24 offset:45056
    ds_read_b64_tr_b16 v[122:123], v24 offset:45568
    v_mfma_f32_16x16x32_bf16 v[128:131], v[72:75], v[52:55], v[128:131]
    s_add_u32 m0, s25, 98304
    s_nop 0
    buffer_load_dwordx4 v8, s[8:11], s26 offen  lds
    s_add_u32 m0, s25, 114688
    s_nop 0
    buffer_load_dwordx4 v10, s[12:15], s27 offen  lds
    s_add_u32 m0, s25, 99328
    s_nop 0
    buffer_load_dwordx4 v9, s[8:11], s26 offen  lds
    v_mfma_f32_16x16x32_bf16 v[132:135], v[72:75], v[56:59], v[132:135]
    s_add_u32 m0, s25, 115712
    s_nop 0
    buffer_load_dwordx4 v11, s[12:15], s27 offen  lds
    s_add_u32 s26, s26, 256
    s_add_u32 s27, s27, 131072
    s_waitcnt vmcnt(4) lgkmcnt(0)
    s_barrier
    v_mfma_f32_16x16x32_bf16 v[128:131], v[108:111], v[76:79], v[128:131]
    ds_read_b128 v[28:31], v20 offset:0
    ds_read_b128 v[32:35], v20 offset:4096
    v_mfma_f32_16x16x32_bf16 v[132:135], v[108:111], v[80:83], v[132:135]
    ds_read_b64_tr_b16 v[60:61], v25 offset:0
    ds_read_b64_tr_b16 v[62:63], v25 offset:512
    v_mfma_f32_16x16x32_bf16 v[128:131], v[112:115], v[84:87], v[128:131]
    ds_read_b128 v[36:39], v21 offset:0
    ds_read_b128 v[40:43], v21 offset:4096
    v_mfma_f32_16x16x32_bf16 v[132:135], v[112:115], v[88:91], v[132:135]
    ds_read_b64_tr_b16 v[64:65], v25 offset:4096
    ds_read_b64_tr_b16 v[66:67], v25 offset:4608
    v_mfma_f32_16x16x32_bf16 v[128:131], v[116:119], v[92:95], v[128:131]
    ds_read_b128 v[44:47], v22 offset:0
    ds_read_b128 v[48:51], v22 offset:4096
    v_mfma_f32_16x16x32_bf16 v[132:135], v[116:119], v[96:99], v[132:135]
    ds_read_b64_tr_b16 v[68:69], v25 offset:8192
    ds_read_b64_tr_b16 v[70:71], v25 offset:8704
    v_mfma_f32_16x16x32_bf16 v[128:131], v[120:123], v[100:103], v[128:131]
    ds_read_b128 v[52:55], v23 offset:0
    ds_read_b128 v[56:59], v23 offset:4096
    v_mfma_f32_16x16x32_bf16 v[132:135], v[120:123], v[104:107], v[132:135]
    ds_read_b64_tr_b16 v[72:73], v25 offset:12288
    ds_read_b64_tr_b16 v[74:75], v25 offset:12800
    s_waitcnt vmcnt(0) lgkmcnt(0)
    s_barrier
    v_mfma_f32_16x16x32_bf16 v[128:131], v[60:63], v[28:31], v[128:131]
    ds_read_b128 v[76:79], v20 offset:32768
    ds_read_b128 v[80:83], v20 offset:36864
    v_mfma_f32_16x16x32_bf16 v[132:135], v[60:63], v[32:35], v[132:135]
    ds_read_b64_tr_b16 v[108:109], v25 offset:32768
    ds_read_b64_tr_b16 v[110:111], v25 offset:33280
    v_mfma_f32_16x16x32_bf16 v[128:131], v[64:67], v[36:39], v[128:131]
    ds_read_b128 v[84:87], v21 offset:32768
    ds_read_b128 v[88:91], v21 offset:36864
    v_mfma_f32_16x16x32_bf16 v[132:135], v[64:67], v[40:43], v[132:135]
    ds_read_b64_tr_b16 v[112:113], v25 offset:36864
    ds_read_b64_tr_b16 v[114:115], v25 offset:37376
    v_mfma_f32_16x16x32_bf16 v[128:131], v[68:71], v[44:47], v[128:131]
    ds_read_b128 v[92:95], v22 offset:32768
    ds_read_b128 v[96:99], v22 offset:36864
    v_mfma_f32_16x16x32_bf16 v[132:135], v[68:71], v[48:51], v[132:135]
    ds_read_b64_tr_b16 v[116:117], v25 offset:40960
    ds_read_b64_tr_b16 v[118:119], v25 offset:41472
    v_mfma_f32_16x16x32_bf16 v[128:131], v[72:75], v[52:55], v[128:131]
    ds_read_b128 v[100:103], v23 offset:32768
    ds_read_b128 v[104:107], v23 offset:36864
    v_mfma_f32_16x16x32_bf16 v[132:135], v[72:75], v[56:59], v[132:135]
    ds_read_b64_tr_b16 v[120:121], v25 offset:45056
    ds_read_b64_tr_b16 v[122:123], v25 offset:45568
    s_waitcnt vmcnt(0) lgkmcnt(0)
    v_mfma_f32_16x16x32_bf16 v[128:131], v[108:111], v[76:79], v[128:131]
    v_mfma_f32_16x16x32_bf16 v[132:135], v[108:111], v[80:83], v[132:135]
    v_mfma_f32_16x16x32_bf16 v[128:131], v[112:115], v[84:87], v[128:131]
    v_mfma_f32_16x16x32_bf16 v[132:135], v[112:115], v[88:91], v[132:135]
    v_mfma_f32_16x16x32_bf16 v[128:131], v[116:119], v[92:95], v[128:131]
    v_mfma_f32_16x16x32_bf16 v[132:135], v[116:119], v[96:99], v[132:135]
    v_mfma_f32_16x16x32_bf16 v[128:131], v[120:123], v[100:103], v[128:131]
    v_mfma_f32_16x16x32_bf16 v[132:135], v[120:123], v[104:107], v[132:135]
    s_nop 7
    s_nop 1
    v_lshlrev_b32 v12, 16, v136
    v_and_b32 v13, 0xffff0000, v136
    v_lshlrev_b32 v14, 16, v137
    v_and_b32 v15, 0xffff0000, v137
    v_add_f32 v12, v12, v128
    v_add_f32 v13, v13, v129
    v_add_f32 v14, v14, v130
    v_add_f32 v15, v15, v131
    v_cvt_pk_bf16_f32 v136, v12, v13
    v_cvt_pk_bf16_f32 v137, v14, v15
    buffer_store_dwordx2 v[136:137], v6, s[44:47], s30 offen
    v_lshlrev_b32 v12, 16, v138
    v_and_b32 v13, 0xffff0000, v138
    v_lshlrev_b32 v14, 16, v139
    v_and_b32 v15, 0xffff0000, v139
    v_add_f32 v12, v12, v132
    v_add_f32 v13, v13, v133
    v_add_f32 v14, v14, v134
    v_add_f32 v15, v15, v135
    v_cvt_pk_bf16_f32 v138, v12, v13
    v_cvt_pk_bf16_f32 v139, v14, v15
    buffer_store_dwordx2 v[138:139], v7, s[44:47], s30 offen
k_wo_kernel_done:
    s_endpgm
.text
.globl k_gu_kernel
.p2align 8
.type k_gu_kernel,@function
k_gu_kernel:
    s_cmp_ge_u32 s2, 256
    s_cbranch_scc1 k_gu_kernel_done
    s_load_dwordx4 s[32:35], s[0:1], 0
    s_load_dwordx4 s[36:39], s[0:1], 32
    s_load_dwordx2 s[40:41], s[0:1], 72
    v_lshrrev_b32 v1, 6, v0
    v_and_b32 v2, 63, v0
    s_nop 0
    v_readfirstlane_b32 s20, v1
    s_and_b32 s22, s2, 3
    s_lshl_b32 s22, s22, 3
    s_bfe_u32 s21, s2, 0x30003
    s_add_u32 s22, s22, s21
    s_bfe_u32 s21, s2, 0x10002
    s_lshl_b32 s21, s21, 2
    s_lshr_b32 s100, s2, 6
    s_add_u32 s21, s21, s100
    s_lshr_b32 s23, s20, 2
    s_and_b32 s24, s20, 3
    s_waitcnt lgkmcnt(0)
    s_add_u32 s8, s40, 8388608
    s_addc_u32 s9, s41, 0
    s_mov_b32 s10, 2097152
    s_mov_b32 s11, 0x00020000
    s_cmp_eq_u32 s23, 0
    s_cselect_b32 s42, s36, s38
    s_cselect_b32 s43, s37, s39
    s_mov_b32 s12, s42
    s_mov_b32 s13, s43
    s_mov_b32 s14, 1409024
    s_mov_b32 s15, 0x00020000
    s_add_u32 s16, s40, 10485760
    s_addc_u32 s17, s41, 0
    s_mov_b32 s18, 5636096
    s_mov_b32 s19, 0x00020000
    v_lshrrev_b32 v4, 3, v2
    v_and_b32 v5, 7, v2
    s_lshl_b32 s27, s20, 3
    v_add_u32 v6, s27, v4
    v_lshlrev_b32 v3, 10, v6
    v_lshl_add_u32 v3, v5, 4, v3
    s_lshl_b32 s27, s22, 16
    buffer_load_dwordx4 v[176:179], v3, s[8:11], s27 offen offset:0
    buffer_load_dwordx4 v[180:183], v3, s[8:11], s27 offen offset:128
    buffer_load_dwordx4 v[184:187], v3, s[8:11], s27 offen offset:256
    buffer_load_dwordx4 v[188:191], v3, s[8:11], s27 offen offset:384
    buffer_load_dwordx4 v[192:195], v3, s[8:11], s27 offen offset:512
    buffer_load_dwordx4 v[196:199], v3, s[8:11], s27 offen offset:640
    buffer_load_dwordx4 v[200:203], v3, s[8:11], s27 offen offset:768
    buffer_load_dwordx4 v[204:207], v3, s[8:11], s27 offen offset:896
    s_mul_i32 s28, s24, 192
    v_add_u32 v11, s28, v2
    v_mul_u32_u24 v12, 2731, v11
    v_lshrrev_b32 v12, 16, v12
    v_mul_u32_u24 v13, 24, v12
    v_sub_u32 v13, v11, v13
    v_bfe_u32 v14, v12, 1, 1
    v_bfe_u32 v15, v12, 3, 1
    v_lshl_or_b32 v14, v15, 1, v14
    v_lshlrev_b32 v14, 1, v14
    v_xor_b32 v13, v13, v14
    s_mov_b32 s27, 2752
    v_mul_lo_u32 v12, v12, s27
    v_lshl_add_u32 v8, v13, 4, v12
    v_add_u32 v11, s28, v2
    v_add_u32 v11, 64, v11
    v_mul_u32_u24 v12, 2731, v11
    v_lshrrev_b32 v12, 16, v12
    v_mul_u32_u24 v13, 24, v12
    v_sub_u32 v13, v11, v13
    v_bfe_u32 v14, v12, 1, 1
    v_bfe_u32 v15, v12, 3, 1
    v_lshl_or_b32 v14, v15, 1, v14
    v_lshlrev_b32 v14, 1, v14
    v_xor_b32 v13, v13, v14
    s_mov_b32 s27, 2752
    v_mul_lo_u32 v12, v12, s27
    v_lshl_add_u32 v9, v13, 4, v12
    v_add_u32 v11, s28, v2
    v_add_u32 v11, 128, v11
    v_mul_u32_u24 v12, 2731, v11
    v_lshrrev_b32 v12, 16, v12
    v_mul_u32_u24 v13, 24, v12
    v_sub_u32 v13, v11, v13
    v_bfe_u32 v14, v12, 1, 1
    v_bfe_u32 v15, v12, 3, 1
    v_lshl_or_b32 v14, v15, 1, v14
    v_lshlrev_b32 v14, 1, v14
    v_xor_b32 v13, v13, v14
    s_mov_b32 s27, 2752
    v_mul_lo_u32 v12, v12, s27
    v_lshl_add_u32 v10, v13, 4, v12
    s_mul_i32 s26, s21, 384
    s_mul_i32 s25, s20, 3072
    s_add_u32 s25, s25, 65536
    s_add_u32 m0, s25, 0
    s_nop 0
    buffer_load_dwordx4 v8, s[12:15], s26 offen  lds
    s_add_u32 m0, s25, 1024
    s_nop 0
    buffer_load_dwordx4 v9, s[12:15], s26 offen  lds
    s_add_u32 m0, s25, 2048
    s_nop 0
    buffer_load_dwordx4 v10, s[12:15], s26 offen  lds
    s_add_u32 s26, s26, 88064
    v_mov_b32 v28, v4
    v_mov_b32 v29, v5
    v_mov_b32 v30, v6
    v_and_b32 v4, 15, v2
    v_lshrrev_b32 v5, 4, v2
    s_lshl_b32 s27, s23, 15
    v_lshlrev_b32 v6, 10, v4
    v_add_u32 v6, s27, v6
    v_and_b32 v7, 3, v4
    v_xor_b32 v7, v7, v5
    v_lshrrev_b32 v11, 2, v4
    v_xor_b32 v12, 0, v11
    v_lshl_or_b32 v12, v12, 2, v7
    v_lshl_add_u32 v24, v12, 4, v6
    v_xor_b32 v12, 1, v11
    v_lshl_or_b32 v12, v12, 2, v7
    v_lshl_add_u32 v25, v12, 4, v6
    v_xor_b32 v12, 2, v11
    v_lshl_or_b32 v12, v12, 2, v7
    v_lshl_add_u32 v26, v12, 4, v6
    v_xor_b32 v12, 3, v11
    v_lshl_or_b32 v12, v12, 2, v7
    v_lshl_add_u32 v27, v12, 4, v6
    v_lshrrev_b32 v11, 2, v4
    v_and_b32 v12, 3, v4
    v_lshl_add_u32 v13, v5, 3, v11
    v_mul_u32_u24 v13, 384, v13
    v_lshl_add_u32 v13, v12, 3, v13
    v_add_u32 v13, 65536, v13
    v_lshrrev_b32 v14, 1, v11
    v_and_b32 v15, 1, v5
    v_lshl_or_b32 v14, v15, 1, v14
    s_mul_i32 s27, s24, 3
    s_add_u32 s28, s27, 0
    v_xor_b32 v15, s28, v14
    v_lshl_add_u32 v16, v15, 5, v13
    v_add_u32 v19, 49152, v16
    s_add_u32 s28, s27, 1
    v_xor_b32 v15, s28, v14
    v_lshl_add_u32 v17, v15, 5, v13
    v_add_u32 v20, 49152, v17
    s_add_u32 s28, s27, 2
    v_xor_b32 v15, s28, v14
    v_lshl_add_u32 v18, v15, 5, v13
    v_add_u32 v21, 49152, v18
    v_mov_b32 v128, 0
    v_mov_b32 v129, 0
    v_mov_b32 v130, 0
    v_mov_b32 v131, 0
    v_mov_b32 v132, 0
    v_mov_b32 v133, 0
    v_mov_b32 v134, 0
    v_mov_b32 v135, 0
    v_mov_b32 v136, 0
    v_mov_b32 v137, 0
    v_mov_b32 v138, 0
    v_mov_b32 v139, 0
    v_mov_b32 v140, 0
    v_mov_b32 v141, 0
    v_mov_b32 v142, 0
    v_mov_b32 v143, 0
    v_mov_b32 v144, 0
    v_mov_b32 v145, 0
    v_mov_b32 v146, 0
    v_mov_b32 v147, 0
    v_mov_b32 v148, 0
    v_mov_b32 v149, 0
    v_mov_b32 v150, 0
    v_mov_b32 v151, 0
    v_mov_b32 v152, 0
    v_mov_b32 v153, 0
    v_mov_b32 v154, 0
    v_mov_b32 v155, 0
    v_mov_b32 v156, 0
    v_mov_b32 v157, 0
    v_mov_b32 v158, 0
    v_mov_b32 v159, 0
    v_mov_b32 v160, 0
    v_mov_b32 v161, 0
    v_mov_b32 v162, 0
    v_mov_b32 v163, 0
    v_mov_b32 v164, 0
    v_mov_b32 v165, 0
    v_mov_b32 v166, 0
    v_mov_b32 v167, 0
    v_mov_b32 v168, 0
    v_mov_b32 v169, 0
    v_mov_b32 v170, 0
    v_mov_b32 v171, 0
    v_mov_b32 v172, 0
    v_mov_b32 v173, 0
    v_mov_b32 v174, 0
    v_mov_b32 v175, 0
    s_waitcnt vmcnt(3)
    s_mov_b32 s31, 0x3f803f80
    v_dot2_f32_bf16 v214, v176, s31, 0
    v_dot2_f32_bf16 v215, v177, s31, 0
    v_dot2_f32_bf16 v216, v176, v176, 0
    v_dot2_f32_bf16 v217, v177, v177, 0
    v_dot2_f32_bf16 v214, v178, s31, v214
    v_dot2_f32_bf16 v215, v179, s31, v215
    v_dot2_f32_bf16 v216, v178, v178, v216
    v_dot2_f32_bf16 v217, v179, v179, v217
    v_dot2_f32_bf16 v214, v180, s31, v214
    v_dot2_f32_bf16 v215, v181, s31, v215
    v_dot2_f32_bf16 v216, v180, v180, v216
    v_dot2_f32_bf16 v217, v181, v181, v217
    v_dot2_f32_bf16 v214, v182, s31, v214
    v_dot2_f32_bf16 v215, v183, s31, v215
    v_dot2_f32_bf16 v216, v182, v182, v216
    v_dot2_f32_bf16 v217, v183, v183, v217
    v_dot2_f32_bf16 v214, v184, s31, v214
    v_dot2_f32_bf16 v215, v185, s31, v215
    v_dot2_f32_bf16 v216, v184, v184, v216
    v_dot2_f32_bf16 v217, v185, v185, v217
    v_dot2_f32_bf16 v214, v186, s31, v214
    v_dot2_f32_bf16 v215, v187, s31, v215
    v_dot2_f32_bf16 v216, v186, v186, v216
    v_dot2_f32_bf16 v217, v187, v187, v217
    v_dot2_f32_bf16 v214, v188, s31, v214
    v_dot2_f32_bf16 v215, v189, s31, v215
    v_dot2_f32_bf16 v216, v188, v188, v216
    v_dot2_f32_bf16 v217, v189, v189, v217
    v_dot2_f32_bf16 v214, v190, s31, v214
    v_dot2_f32_bf16 v215, v191, s31, v215
    v_dot2_f32_bf16 v216, v190, v190, v216
    v_dot2_f32_bf16 v217, v191, v191, v217
    v_dot2_f32_bf16 v214, v192, s31, v214
    v_dot2_f32_bf16 v215, v193, s31, v215
    v_dot2_f32_bf16 v216, v192, v192, v216
    v_dot2_f32_bf16 v217, v193, v193, v217
    v_dot2_f32_bf16 v214, v194, s31, v214
    v_dot2_f32_bf16 v215, v195, s31, v215
    v_dot2_f32_bf16 v216, v194, v194, v216
    v_dot2_f32_bf16 v217, v195, v195, v217
    v_dot2_f32_bf16 v214, v196, s31, v214
    v_dot2_f32_bf16 v215, v197, s31, v215
    v_dot2_f32_bf16 v216, v196, v196, v216
    v_dot2_f32_bf16 v217, v197, v197, v217
    v_dot2_f32_bf16 v214, v198, s31, v214
    v_dot2_f32_bf16 v215, v199, s31, v215
    v_dot2_f32_bf16 v216, v198, v198, v216
    v_dot2_f32_bf16 v217, v199, v199, v217
    v_dot2_f32_bf16 v214, v200, s31, v214
    v_dot2_f32_bf16 v215, v201, s31, v215
    v_dot2_f32_bf16 v216, v200, v200, v216
    v_dot2_f32_bf16 v217, v201, v201, v217
    v_dot2_f32_bf16 v214, v202, s31, v214
    v_dot2_f32_bf16 v215, v203, s31, v215
    v_dot2_f32_bf16 v216, v202, v202, v216
    v_dot2_f32_bf16 v217, v203, v203, v217
    v_dot2_f32_bf16 v214, v204, s31, v214
    v_dot2_f32_bf16 v215, v205, s31, v215
    v_dot2_f32_bf16 v216, v204, v204, v216
    v_dot2_f32_bf16 v217, v205, v205, v217
    v_dot2_f32_bf16 v214, v206, s31, v214
    v_dot2_f32_bf16 v215, v207, s31, v215
    v_dot2_f32_bf16 v216, v206, v206, v216
    v_dot2_f32_bf16 v217, v207, v207, v217
    s_nop 3
    v_add_f32 v214, v214, v215
    v_add_f32 v216, v216, v217
    s_nop 1
    v_add_f32_dpp v214, v214, v214 quad_perm:[1,0,3,2] row_mask:0xf bank_mask:0xf
    v_add_f32_dpp v216, v216, v216 quad_perm:[1,0,3,2] row_mask:0xf bank_mask:0xf
    s_nop 1
    v_add_f32_dpp v214, v214, v214 quad_perm:[2,3,0,1] row_mask:0xf bank_mask:0xf
    v_add_f32_dpp v216, v216, v216 quad_perm:[2,3,0,1] row_mask:0xf bank_mask:0xf
    s_nop 1
    v_add_f32_dpp v214, v214, v214 row_half_mirror row_mask:0xf bank_mask:0xf
    v_add_f32_dpp v216, v216, v216 row_half_mirror row_mask:0xf bank_mask:0xf
    s_add_u32 m0, s25, 24576
    s_nop 0
    buffer_load_dwordx4 v8, s[12:15], s26 offen  lds
    s_add_u32 m0, s25, 25600
    s_nop 0
    buffer_load_dwordx4 v9, s[12:15], s26 offen  lds
    s_add_u32 m0, s25, 26624
    s_nop 0
    buffer_load_dwordx4 v10, s[12:15], s26 offen  lds
    s_add_u32 s26, s26, 88064
    v_mul_f32 v214, 0x3b000000, v214
    v_mul_f32 v216, 0x3b000000, v216
    v_fma_f32 v216, -v214, v214, v216
    v_max_f32 v216, 0, v216
    v_add_f32 v216, 0x3727c5ac, v216
    v_rsq_f32 v208, v216
    s_nop 0
    v_mul_f32 v209, v214, v208
    v_sub_f32 v209, 0, v209
    v_xor_b32 v218, v28, v29
    s_and_b32 s27, s20, 1
    s_lshl_b32 s27, s27, 3
    v_add_u32 v219, s27, v218
    s_xor_b32 s27, s27, 8
    v_add_u32 v220, s27, v218
    v_lshlrev_b32 v210, 10, v30
    v_lshl_add_u32 v211, v220, 4, v210
    v_lshl_add_u32 v210, v219, 4, v210
    v_lshlrev_b32 v212, 16, v176
    v_and_b32 v213, 0xffff0000, v176
    v_fma_f32 v212, v212, v208, v209
    v_fma_f32 v213, v213, v208, v209
    v_cvt_pk_bf16_f32 v176, v212, v213
    v_lshlrev_b32 v212, 16, v177
    v_and_b32 v213, 0xffff0000, v177
    v_fma_f32 v212, v212, v208, v209
    v_fma_f32 v213, v213, v208, v209
    v_cvt_pk_bf16_f32 v177, v212, v213
    v_lshlrev_b32 v212, 16, v178
    v_and_b32 v213, 0xffff0000, v178
    v_fma_f32 v212, v212, v208, v209
    v_fma_f32 v213, v213, v208, v209
    v_cvt_pk_bf16_f32 v178, v212, v213
    v_lshlrev_b32 v212, 16, v179
    v_and_b32 v213, 0xffff0000, v179
    v_fma_f32 v212, v212, v208, v209
    v_fma_f32 v213, v213, v208, v209
    v_cvt_pk_bf16_f32 v179, v212, v213
    ds_write_b128 v210, v[176:179] offset:0
    v_lshlrev_b32 v212, 16, v180
    v_and_b32 v213, 0xffff0000, v180
    v_fma_f32 v212, v212, v208, v209
    v_fma_f32 v213, v213, v208, v209
    v_cvt_pk_bf16_f32 v180, v212, v213
    v_lshlrev_b32 v212, 16, v181
    v_and_b32 v213, 0xffff0000, v181
    v_fma_f32 v212, v212, v208, v209
    v_fma_f32 v213, v213, v208, v209
    v_cvt_pk_bf16_f32 v181, v212, v213
    v_lshlrev_b32 v212, 16, v182
    v_and_b32 v213, 0xffff0000, v182
    v_fma_f32 v212, v212, v208, v209
    v_fma_f32 v213, v213, v208, v209
    v_cvt_pk_bf16_f32 v182, v212, v213
    v_lshlrev_b32 v212, 16, v183
    v_and_b32 v213, 0xffff0000, v183
    v_fma_f32 v212, v212, v208, v209
    v_fma_f32 v213, v213, v208, v209
    v_cvt_pk_bf16_f32 v183, v212, v213
    ds_write_b128 v211, v[180:183] offset:0
    s_waitcnt vmcnt(3) lgkmcnt(0)
    s_barrier
    ds_read_b128 v[32:35], v24 offset:0
    ds_read_b128 v[36:39], v24 offset:16384
    ds_read_b64_tr_b16 v[48:49], v16 offset:0
    ds_read_b64_tr_b16 v[50:51], v16 offset:1536
    ds_read_b64_tr_b16 v[52:53], v17 offset:0
    ds_read_b64_tr_b16 v[54:55], v17 offset:1536
    ds_read_b64_tr_b16 v[56:57], v18 offset:0
    ds_read_b64_tr_b16 v[58:59], v18 offset:1536
    ds_read_b64_tr_b16 v[60:61], v16 offset:12288
    ds_read_b64_tr_b16 v[62:63], v16 offset:13824
    ds_read_b64_tr_b16 v[64:65], v17 offset:12288
    ds_read_b64_tr_b16 v[66:67], v17 offset:13824
    ds_read_b64_tr_b16 v[68:69], v18 offset:12288
    ds_read_b64_tr_b16 v[70:71], v18 offset:13824
    s_add_u32 m0, s25, 49152
    s_nop 0
    buffer_load_dwordx4 v8, s[12:15], s26 offen  lds
    s_add_u32 m0, s25, 50176
    s_nop 0
    buffer_load_dwordx4 v9, s[12:15], s26 offen  lds
    s_add_u32 m0, s25, 51200
    s_nop 0
    buffer_load_dwordx4 v10, s[12:15], s26 offen  lds
    s_add_u32 s26, s26, 88064
    v_lshlrev_b32 v212, 16, v184
    v_and_b32 v213, 0xffff0000, v184
    v_fma_f32 v212, v212, v208, v209
    v_fma_f32 v213, v213, v208, v209
    v_cvt_pk_bf16_f32 v184, v212, v213
    v_lshlrev_b32 v212, 16, v185
    v_and_b32 v213, 0xffff0000, v185
    v_fma_f32 v212, v212, v208, v209
    v_fma_f32 v213, v213, v208, v209
    v_cvt_pk_bf16_f32 v185, v212, v213
    v_lshlrev_b32 v212, 16, v186
    v_and_b32 v213, 0xffff0000, v186
    v_fma_f32 v212, v212, v208, v209
    v_fma_f32 v213, v213, v208, v209
    v_cvt_pk_bf16_f32 v186, v212, v213
    v_lshlrev_b32 v212, 16, v187
    v_and_b32 v213, 0xffff0000, v187
    v_fma_f32 v212, v212, v208, v209
    v_fma_f32 v213, v213, v208, v209
    v_cvt_pk_bf16_f32 v187, v212, v213
    ds_write_b128 v210, v[184:187] offset:256
    s_waitcnt vmcnt(3) lgkmcnt(0)
    s_barrier
    v_mfma_f32_16x16x32_bf16 v[128:131], v[48:51], v[32:35], v[128:131]
    ds_read_b128 v[80:83], v25 offset:0
    v_mfma_f32_16x16x32_bf16 v[140:143], v[48:51], v[36:39], v[140:143]
    ds_read_b128 v[84:87], v25 offset:16384
    ds_read_b64_tr_b16 v[96:97], v16 offset:24576
    v_mfma_f32_16x16x32_bf16 v[132:135], v[52:55], v[32:35], v[132:135]
    ds_read_b64_tr_b16 v[98:99], v16 offset:26112
    v_mfma_f32_16x16x32_bf16 v[144:147], v[52:55], v[36:39], v[144:147]
    ds_read_b64_tr_b16 v[100:101], v17 offset:24576
    ds_read_b64_tr_b16 v[102:103], v17 offset:26112
    v_mfma_f32_16x16x32_bf16 v[136:139], v[56:59], v[32:35], v[136:139]
    ds_read_b64_tr_b16 v[104:105], v18 offset:24576
    v_mfma_f32_16x16x32_bf16 v[148:151], v[56:59], v[36:39], v[148:151]
    ds_read_b64_tr_b16 v[106:107], v18 offset:26112
    ds_read_b64_tr_b16 v[108:109], v16 offset:36864
    v_mfma_f32_16x16x32_bf16 v[152:155], v[60:63], v[32:35], v[152:155]
    ds_read_b64_tr_b16 v[110:111], v16 offset:38400
    v_mfma_f32_16x16x32_bf16 v[164:167], v[60:63], v[36:39], v[164:167]
    ds_read_b64_tr_b16 v[112:113], v17 offset:36864
    ds_read_b64_tr_b16 v[114:115], v17 offset:38400
    v_mfma_f32_16x16x32_bf16 v[156:159], v[64:67], v[32:35], v[156:159]
    ds_read_b64_tr_b16 v[116:117], v18 offset:36864
    v_mfma_f32_16x16x32_bf16 v[168:171], v[64:67], v[36:39], v[168:171]
    ds_read_b64_tr_b16 v[118:119], v18 offset:38400
    s_add_u32 m0, s25, 73728
    s_nop 0
    buffer_load_dwordx4 v8, s[12:15], s26 offen  lds
    v_mfma_f32_16x16x32_bf16 v[160:163], v[68:71], v[32:35], v[160:163]
    s_add_u32 m0, s25, 74752
    s_nop 0
    buffer_load_dwordx4 v9, s[12:15], s26 offen  lds
    v_mfma_f32_16x16x32_bf16 v[172:175], v[68:71], v[36:39], v[172:175]
    s_add_u32 m0, s25, 75776
    s_nop 0
    buffer_load_dwordx4 v10, s[12:15], s26 offen  lds
    s_add_u32 s26, s26, 88064
    s_waitcnt vmcnt(3) lgkmcnt(0)
    s_barrier
    v_mfma_f32_16x16x32_bf16 v[128:131], v[96:99], v[80:83], v[128:131]
    ds_read_b128 v[32:35], v26 offset:0
    ds_read_b128 v[36:39], v26 offset:16384
    ds_read_b64_tr_b16 v[48:49], v19 offset:0
    v_mfma_f32_16x16x32_bf16 v[140:143], v[96:99], v[84:87], v[140:143]
    ds_read_b64_tr_b16 v[50:51], v19 offset:1536
    ds_read_b64_tr_b16 v[52:53], v20 offset:0
    ds_read_b64_tr_b16 v[54:55], v20 offset:1536
    v_mfma_f32_16x16x32_bf16 v[132:135], v[100:103], v[80:83], v[132:135]
    ds_read_b64_tr_b16 v[56:57], v21 offset:0
    ds_read_b64_tr_b16 v[58:59], v21 offset:1536
    ds_read_b64_tr_b16 v[60:61], v19 offset:12288
    v_mfma_f32_16x16x32_bf16 v[144:147], v[100:103], v[84:87], v[144:147]
    ds_read_b64_tr_b16 v[62:63], v19 offset:13824
    ds_read_b64_tr_b16 v[64:65], v20 offset:12288
    ds_read_b64_tr_b16 v[66:67], v20 offset:13824
    ds_read_b64_tr_b16 v[68:69], v21 offset:12288
    v_mfma_f32_16x16x32_bf16 v[136:139], v[104:107], v[80:83], v[136:139]
    ds_read_b64_tr_b16 v[70:71], v21 offset:13824
    s_add_u32 m0, s25, 0
    s_nop 0
    buffer_load_dwordx4 v8, s[12:15], s26 offen  lds
    s_add_u32 m0, s25, 1024
    s_nop 0
    buffer_load_dwordx4 v9, s[12:15], s26 offen  lds
    v_mfma_f32_16x16x32_bf16 v[148:151], v[104:107], v[84:87], v[148:151]
    s_add_u32 m0, s25, 2048
    s_nop 0
    buffer_load_dwordx4 v10, s[12:15], s26 offen  lds
    s_add_u32 s26, s26, 88064
    v_lshlrev_b32 v212, 16, v188
    v_mfma_f32_16x16x32_bf16 v[152:155], v[108:111], v[80:83], v[152:155]
    v_and_b32 v213, 0xffff0000, v188
    v_fma_f32 v212, v212, v208, v209
    v_fma_f32 v213, v213, v208, v209
    v_mfma_f32_16x16x32_bf16 v[164:167], v[108:111], v[84:87], v[164:167]
    v_cvt_pk_bf16_f32 v188, v212, v213
    v_lshlrev_b32 v212, 16, v189
    v_and_b32 v213, 0xffff0000, v189
    v_fma_f32 v212, v212, v208, v209
    v_mfma_f32_16x16x32_bf16 v[156:159], v[112:115], v[80:83], v[156:159]
    v_fma_f32 v213, v213, v208, v209
    v_cvt_pk_bf16_f32 v189, v212, v213
    v_lshlrev_b32 v212, 16, v190
    v_mfma_f32_16x16x32_bf16 v[168:171], v[112:115], v[84:87], v[168:171]
    v_and_b32 v213, 0xffff0000, v190
    v_fma_f32 v212, v212, v208, v209
    v_fma_f32 v213, v213, v208, v209
    v_mfma_f32_16x16x32_bf16 v[160:163], v[116:119], v[80:83], v[160:163]
    v_cvt_pk_bf16_f32 v190, v212, v213
    v_lshlrev_b32 v212, 16, v191
    v_and_b32 v213, 0xffff0000, v191
    v_mfma_f32_16x16x32_bf16 v[172:175], v[116:119], v[84:87], v[172:175]
    v_fma_f32 v212, v212, v208, v209
    v_fma_f32 v213, v213, v208, v209
    v_cvt_pk_bf16_f32 v191, v212, v213
    ds_write_b128 v211, v[188:191] offset:256
    s_waitcnt vmcnt(3) lgkmcnt(0)
    s_barrier
    v_mfma_f32_16x16x32_bf16 v[128:131], v[48:51], v[32:35], v[128:131]
    ds_read_b128 v[80:83], v27 offset:0
    v_mfma_f32_16x16x32_bf16 v[140:143], v[48:51], v[36:39], v[140:143]
    ds_read_b128 v[84:87], v27 offset:16384
    ds_read_b64_tr_b16 v[96:97], v19 offset:24576
    v_mfma_f32_16x16x32_bf16 v[132:135], v[52:55], v[32:35], v[132:135]
    ds_read_b64_tr_b16 v[98:99], v19 offset:26112
    v_mfma_f32_16x16x32_bf16 v[144:147], v[52:55], v[36:39], v[144:147]
    ds_read_b64_tr_b16 v[100:101], v20 offset:24576
    ds_read_b64_tr_b16 v[102:103], v20 offset:26112
    v_mfma_f32_16x16x32_bf16 v[136:139], v[56:59], v[32:35], v[136:139]
    ds_read_b64_tr_b16 v[104:105], v21 offset:24576
    v_mfma_f32_16x16x32_bf16 v[148:151], v[56:59], v[36:39], v[148:151]
    ds_read_b64_tr_b16 v[106:107], v21 offset:26112
    ds_read_b64_tr_b16 v[108:109], v19 offset:36864
    v_mfma_f32_16x16x32_bf16 v[152:155], v[60:63], v[32:35], v[152:155]
    ds_read_b64_tr_b16 v[110:111], v19 offset:38400
    v_mfma_f32_16x16x32_bf16 v[164:167], v[60:63], v[36:39], v[164:167]
    ds_read_b64_tr_b16 v[112:113], v20 offset:36864
    ds_read_b64_tr_b16 v[114:115], v20 offset:38400
    v_mfma_f32_16x16x32_bf16 v[156:159], v[64:67], v[32:35], v[156:159]
    ds_read_b64_tr_b16 v[116:117], v21 offset:36864
    v_mfma_f32_16x16x32_bf16 v[168:171], v[64:67], v[36:39], v[168:171]
    ds_read_b64_tr_b16 v[118:119], v21 offset:38400
    s_add_u32 m0, s25, 24576
    s_nop 0
    buffer_load_dwordx4 v8, s[12:15], s26 offen  lds
    v_mfma_f32_16x16x32_bf16 v[160:163], v[68:71], v[32:35], v[160:163]
    s_add_u32 m0, s25, 25600
    s_nop 0
    buffer_load_dwordx4 v9, s[12:15], s26 offen  lds
    v_mfma_f32_16x16x32_bf16 v[172:175], v[68:71], v[36:39], v[172:175]
    s_add_u32 m0, s25, 26624
    s_nop 0
    buffer_load_dwordx4 v10, s[12:15], s26 offen  lds
    s_add_u32 s26, s26, 88064
    s_waitcnt vmcnt(3) lgkmcnt(0)
    s_barrier
    v_mfma_f32_16x16x32_bf16 v[128:131], v[96:99], v[80:83], v[128:131]
    ds_read_b128 v[32:35], v24 offset:256
    ds_read_b128 v[36:39], v24 offset:16640
    ds_read_b64_tr_b16 v[48:49], v16 offset:0
    v_mfma_f32_16x16x32_bf16 v[140:143], v[96:99], v[84:87], v[140:143]
    ds_read_b64_tr_b16 v[50:51], v16 offset:1536
    ds_read_b64_tr_b16 v[52:53], v17 offset:0
    ds_read_b64_tr_b16 v[54:55], v17 offset:1536
    v_mfma_f32_16x16x32_bf16 v[132:135], v[100:103], v[80:83], v[132:135]
    ds_read_b64_tr_b16 v[56:57], v18 offset:0
    ds_read_b64_tr_b16 v[58:59], v18 offset:1536
    ds_read_b64_tr_b16 v[60:61], v16 offset:12288
    v_mfma_f32_16x16x32_bf16 v[144:147], v[100:103], v[84:87], v[144:147]
    ds_read_b64_tr_b16 v[62:63], v16 offset:13824
    ds_read_b64_tr_b16 v[64:65], v17 offset:12288
    ds_read_b64_tr_b16 v[66:67], v17 offset:13824
    ds_read_b64_tr_b16 v[68:69], v18 offset:12288
    v_mfma_f32_16x16x32_bf16 v[136:139], v[104:107], v[80:83], v[136:139]
    ds_read_b64_tr_b16 v[70:71], v18 offset:13824
    s_add_u32 m0, s25, 49152
    s_nop 0
    buffer_load_dwordx4 v8, s[12:15], s26 offen  lds
    s_add_u32 m0, s25, 50176
    s_nop 0
    buffer_load_dwordx4 v9, s[12:15], s26 offen  lds
    v_mfma_f32_16x16x32_bf16 v[148:151], v[104:107], v[84:87], v[148:151]
    s_add_u32 m0, s25, 51200
    s_nop 0
    buffer_load_dwordx4 v10, s[12:15], s26 offen  lds
    s_add_u32 s26, s26, 88064
    v_lshlrev_b32 v212, 16, v192
    v_mfma_f32_16x16x32_bf16 v[152:155], v[108:111], v[80:83], v[152:155]
    v_and_b32 v213, 0xffff0000, v192
    v_fma_f32 v212, v212, v208, v209
    v_fma_f32 v213, v213, v208, v209
    v_mfma_f32_16x16x32_bf16 v[164:167], v[108:111], v[84:87], v[164:167]
    v_cvt_pk_bf16_f32 v192, v212, v213
    v_lshlrev_b32 v212, 16, v193
    v_and_b32 v213, 0xffff0000, v193
    v_fma_f32 v212, v212, v208, v209
    v_mfma_f32_16x16x32_bf16 v[156:159], v[112:115], v[80:83], v[156:159]
    v_fma_f32 v213, v213, v208, v209
    v_cvt_pk_bf16_f32 v193, v212, v213
    v_lshlrev_b32 v212, 16, v194
    v_mfma_f32_16x16x32_bf16 v[168:171], v[112:115], v[84:87], v[168:171]
    v_and_b32 v213, 0xffff0000, v194
    v_fma_f32 v212, v212, v208, v209
    v_fma_f32 v213, v213, v208, v209
    v_mfma_f32_16x16x32_bf16 v[160:163], v[116:119], v[80:83], v[160:163]
    v_cvt_pk_bf16_f32 v194, v212, v213
    v_lshlrev_b32 v212, 16, v195
    v_and_b32 v213, 0xffff0000, v195
    v_mfma_f32_16x16x32_bf16 v[172:175], v[116:119], v[84:87], v[172:175]
    v_fma_f32 v212, v212, v208, v209
    v_fma_f32 v213, v213, v208, v209
    v_cvt_pk_bf16_f32 v195, v212, v213
    ds_write_b128 v210, v[192:195] offset:512
    s_waitcnt vmcnt(3) lgkmcnt(0)
    s_barrier
    v_mfma_f32_16x16x32_bf16 v[128:131], v[48:51], v[32:35], v[128:131]
    ds_read_b128 v[80:83], v25 offset:256
    v_mfma_f32_16x16x32_bf16 v[140:143], v[48:51], v[36:39], v[140:143]
    ds_read_b128 v[84:87], v25 offset:16640
    ds_read_b64_tr_b16 v[96:97], v16 offset:24576
    v_mfma_f32_16x16x32_bf16 v[132:135], v[52:55], v[32:35], v[132:135]
    ds_read_b64_tr_b16 v[98:99], v16 offset:26112
    v_mfma_f32_16x16x32_bf16 v[144:147], v[52:55], v[36:39], v[144:147]
    ds_read_b64_tr_b16 v[100:101], v17 offset:24576
    ds_read_b64_tr_b16 v[102:103], v17 offset:26112
    v_mfma_f32_16x16x32_bf16 v[136:139], v[56:59], v[32:35], v[136:139]
    ds_read_b64_tr_b16 v[104:105], v18 offset:24576
    v_mfma_f32_16x16x32_bf16 v[148:151], v[56:59], v[36:39], v[148:151]
    ds_read_b64_tr_b16 v[106:107], v18 offset:26112
    ds_read_b64_tr_b16 v[108:109], v16 offset:36864
    v_mfma_f32_16x16x32_bf16 v[152:155], v[60:63], v[32:35], v[152:155]
    ds_read_b64_tr_b16 v[110:111], v16 offset:38400
    v_mfma_f32_16x16x32_bf16 v[164:167], v[60:63], v[36:39], v[164:167]
    ds_read_b64_tr_b16 v[112:113], v17 offset:36864
    ds_read_b64_tr_b16 v[114:115], v17 offset:38400
    v_mfma_f32_16x16x32_bf16 v[156:159], v[64:67], v[32:35], v[156:159]
    ds_read_b64_tr_b16 v[116:117], v18 offset:36864
    v_mfma_f32_16x16x32_bf16 v[168:171], v[64:67], v[36:39], v[168:171]
    ds_read_b64_tr_b16 v[118:119], v18 offset:38400
    s_add_u32 m0, s25, 73728
    s_nop 0
    buffer_load_dwordx4 v8, s[12:15], s26 offen  lds
    v_mfma_f32_16x16x32_bf16 v[160:163], v[68:71], v[32:35], v[160:163]
    s_add_u32 m0, s25, 74752
    s_nop 0
    buffer_load_dwordx4 v9, s[12:15], s26 offen  lds
    v_mfma_f32_16x16x32_bf16 v[172:175], v[68:71], v[36:39], v[172:175]
    s_add_u32 m0, s25, 75776
    s_nop 0
    buffer_load_dwordx4 v10, s[12:15], s26 offen  lds
    s_add_u32 s26, s26, 88064
    s_waitcnt vmcnt(3) lgkmcnt(0)
    s_barrier
    v_mfma_f32_16x16x32_bf16 v[128:131], v[96:99], v[80:83], v[128:131]
    ds_read_b128 v[32:35], v26 offset:256
    ds_read_b128 v[36:39], v26 offset:16640
    ds_read_b64_tr_b16 v[48:49], v19 offset:0
    v_mfma_f32_16x16x32_bf16 v[140:143], v[96:99], v[84:87], v[140:143]
    ds_read_b64_tr_b16 v[50:51], v19 offset:1536
    ds_read_b64_tr_b16 v[52:53], v20 offset:0
    ds_read_b64_tr_b16 v[54:55], v20 offset:1536
    v_mfma_f32_16x16x32_bf16 v[132:135], v[100:103], v[80:83], v[132:135]
    ds_read_b64_tr_b16 v[56:57], v21 offset:0
    ds_read_b64_tr_b16 v[58:59], v21 offset:1536
    ds_read_b64_tr_b16 v[60:61], v19 offset:12288
    v_mfma_f32_16x16x32_bf16 v[144:147], v[100:103], v[84:87], v[144:147]
    ds_read_b64_tr_b16 v[62:63], v19 offset:13824
    ds_read_b64_tr_b16 v[64:65], v20 offset:12288
    ds_read_b64_tr_b16 v[66:67], v20 offset:13824
    ds_read_b64_tr_b16 v[68:69], v21 offset:12288
    v_mfma_f32_16x16x32_bf16 v[136:139], v[104:107], v[80:83], v[136:139]
    ds_read_b64_tr_b16 v[70:71], v21 offset:13824
    s_add_u32 m0, s25, 0
    s_nop 0
    buffer_load_dwordx4 v8, s[12:15], s26 offen  lds
    s_add_u32 m0, s25, 1024
    s_nop 0
    buffer_load_dwordx4 v9, s[12:15], s26 offen  lds
    v_mfma_f32_16x16x32_bf16 v[148:151], v[104:107], v[84:87], v[148:151]
    s_add_u32 m0, s25, 2048
    s_nop 0
    buffer_load_dwordx4 v10, s[12:15], s26 offen  lds
    s_add_u32 s26, s26, 88064
    v_lshlrev_b32 v212, 16, v196
    v_mfma_f32_16x16x32_bf16 v[152:155], v[108:111], v[80:83], v[152:155]
    v_and_b32 v213, 0xffff0000, v196
    v_fma_f32 v212, v212, v208, v209
    v_fma_f32 v213, v213, v208, v209
    v_mfma_f32_16x16x32_bf16 v[164:167], v[108:111], v[84:87], v[164:167]
    v_cvt_pk_bf16_f32 v196, v212, v213
    v_lshlrev_b32 v212, 16, v197
    v_and_b32 v213, 0xffff0000, v197
    v_fma_f32 v212, v212, v208, v209
    v_mfma_f32_16x16x32_bf16 v[156:159], v[112:115], v[80:83], v[156:159]
    v_fma_f32 v213, v213, v208, v209
    v_cvt_pk_bf16_f32 v197, v212, v213
    v_lshlrev_b32 v212, 16, v198
    v_mfma_f32_16x16x32_bf16 v[168:171], v[112:115], v[84:87], v[168:171]
    v_and_b32 v213, 0xffff0000, v198
    v_fma_f32 v212, v212, v208, v209
    v_fma_f32 v213, v213, v208, v209
    v_mfma_f32_16x16x32_bf16 v[160:163], v[116:119], v[80:83], v[160:163]
    v_cvt_pk_bf16_f32 v198, v212, v213
    v_lshlrev_b32 v212, 16, v199
    v_and_b32 v213, 0xffff0000, v199
    v_mfma_f32_16x16x32_bf16 v[172:175], v[116:119], v[84:87], v[172:175]
    v_fma_f32 v212, v212, v208, v209
    v_fma_f32 v213, v213, v208, v209
    v_cvt_pk_bf16_f32 v199, v212, v213
    ds_write_b128 v211, v[196:199] offset:512
    s_waitcnt vmcnt(3) lgkmcnt(0)
    s_barrier
    v_mfma_f32_16x16x32_bf16 v[128:131], v[48:51], v[32:35], v[128:131]
    ds_read_b128 v[80:83], v27 offset:256
    v_mfma_f32_16x16x32_bf16 v[140:143], v[48:51], v[36:39], v[140:143]
    ds_read_b128 v[84:87], v27 offset:16640
    ds_read_b64_tr_b16 v[96:97], v19 offset:24576
    v_mfma_f32_16x16x32_bf16 v[132:135], v[52:55], v[32:35], v[132:135]
    ds_read_b64_tr_b16 v[98:99], v19 offset:26112
    v_mfma_f32_16x16x32_bf16 v[144:147], v[52:55], v[36:39], v[144:147]
    ds_read_b64_tr_b16 v[100:101], v20 offset:24576
    ds_read_b64_tr_b16 v[102:103], v20 offset:26112
    v_mfma_f32_16x16x32_bf16 v[136:139], v[56:59], v[32:35], v[136:139]
    ds_read_b64_tr_b16 v[104:105], v21 offset:24576
    v_mfma_f32_16x16x32_bf16 v[148:151], v[56:59], v[36:39], v[148:151]
    ds_read_b64_tr_b16 v[106:107], v21 offset:26112
    ds_read_b64_tr_b16 v[108:109], v19 offset:36864
    v_mfma_f32_16x16x32_bf16 v[152:155], v[60:63], v[32:35], v[152:155]
    ds_read_b64_tr_b16 v[110:111], v19 offset:38400
    v_mfma_f32_16x16x32_bf16 v[164:167], v[60:63], v[36:39], v[164:167]
    ds_read_b64_tr_b16 v[112:113], v20 offset:36864
    ds_read_b64_tr_b16 v[114:115], v20 offset:38400
    v_mfma_f32_16x16x32_bf16 v[156:159], v[64:67], v[32:35], v[156:159]
    ds_read_b64_tr_b16 v[116:117], v21 offset:36864
    v_mfma_f32_16x16x32_bf16 v[168:171], v[64:67], v[36:39], v[168:171]
    ds_read_b64_tr_b16 v[118:119], v21 offset:38400
    s_add_u32 m0, s25, 24576
    s_nop 0
    buffer_load_dwordx4 v8, s[12:15], s26 offen  lds
    v_mfma_f32_16x16x32_bf16 v[160:163], v[68:71], v[32:35], v[160:163]
    s_add_u32 m0, s25, 25600
    s_nop 0
    buffer_load_dwordx4 v9, s[12:15], s26 offen  lds
    v_mfma_f32_16x16x32_bf16 v[172:175], v[68:71], v[36:39], v[172:175]
    s_add_u32 m0, s25, 26624
    s_nop 0
    buffer_load_dwordx4 v10, s[12:15], s26 offen  lds
    s_add_u32 s26, s26, 88064
    s_waitcnt vmcnt(3) lgkmcnt(0)
    s_barrier
    v_mfma_f32_16x16x32_bf16 v[128:131], v[96:99], v[80:83], v[128:131]
    ds_read_b128 v[32:35], v24 offset:512
    ds_read_b128 v[36:39], v24 offset:16896
    ds_read_b64_tr_b16 v[48:49], v16 offset:0
    v_mfma_f32_16x16x32_bf16 v[140:143], v[96:99], v[84:87], v[140:143]
    ds_read_b64_tr_b16 v[50:51], v16 offset:1536
    ds_read_b64_tr_b16 v[52:53], v17 offset:0
    ds_read_b64_tr_b16 v[54:55], v17 offset:1536
    v_mfma_f32_16x16x32_bf16 v[132:135], v[100:103], v[80:83], v[132:135]
    ds_read_b64_tr_b16 v[56:57], v18 offset:0
    ds_read_b64_tr_b16 v[58:59], v18 offset:1536
    ds_read_b64_tr_b16 v[60:61], v16 offset:12288
    v_mfma_f32_16x16x32_bf16 v[144:147], v[100:103], v[84:87], v[144:147]
    ds_read_b64_tr_b16 v[62:63], v16 offset:13824
    ds_read_b64_tr_b16 v[64:65], v17 offset:12288
    ds_read_b64_tr_b16 v[66:67], v17 offset:13824
    ds_read_b64_tr_b16 v[68:69], v18 offset:12288
    v_mfma_f32_16x16x32_bf16 v[136:139], v[104:107], v[80:83], v[136:139]
    ds_read_b64_tr_b16 v[70:71], v18 offset:13824
    s_add_u32 m0, s25, 49152
    s_nop 0
    buffer_load_dwordx4 v8, s[12:15], s26 offen  lds
    s_add_u32 m0, s25, 50176
    s_nop 0
    buffer_load_dwordx4 v9, s[12:15], s26 offen  lds
    v_mfma_f32_16x16x32_bf16 v[148:151], v[104:107], v[84:87], v[148:151]
    s_add_u32 m0, s25, 51200
    s_nop 0
    buffer_load_dwordx4 v10, s[12:15], s26 offen  lds
    s_add_u32 s26, s26, 88064
    v_lshlrev_b32 v212, 16, v200
    v_mfma_f32_16x16x32_bf16 v[152:155], v[108:111], v[80:83], v[152:155]
    v_and_b32 v213, 0xffff0000, v200
    v_fma_f32 v212, v212, v208, v209
    v_fma_f32 v213, v213, v208, v209
    v_mfma_f32_16x16x32_bf16 v[164:167], v[108:111], v[84:87], v[164:167]
    v_cvt_pk_bf16_f32 v200, v212, v213
    v_lshlrev_b32 v212, 16, v201
    v_and_b32 v213, 0xffff0000, v201
    v_fma_f32 v212, v212, v208, v209
    v_mfma_f32_16x16x32_bf16 v[156:159], v[112:115], v[80:83], v[156:159]
    v_fma_f32 v213, v213, v208, v209
    v_cvt_pk_bf16_f32 v201, v212, v213
    v_lshlrev_b32 v212, 16, v202
    v_mfma_f32_16x16x32_bf16 v[168:171], v[112:115], v[84:87], v[168:171]
    v_and_b32 v213, 0xffff0000, v202
    v_fma_f32 v212, v212, v208, v209
    v_fma_f32 v213, v213, v208, v209
    v_mfma_f32_16x16x32_bf16 v[160:163], v[116:119], v[80:83], v[160:163]
    v_cvt_pk_bf16_f32 v202, v212, v213
    v_lshlrev_b32 v212, 16, v203
    v_and_b32 v213, 0xffff0000, v203
    v_mfma_f32_16x16x32_bf16 v[172:175], v[116:119], v[84:87], v[172:175]
    v_fma_f32 v212, v212, v208, v209
    v_fma_f32 v213, v213, v208, v209
    v_cvt_pk_bf16_f32 v203, v212, v213
    ds_write_b128 v210, v[200:203] offset:768
    s_waitcnt vmcnt(3) lgkmcnt(0)
    s_barrier
    v_mfma_f32_16x16x32_bf16 v[128:131], v[48:51], v[32:35], v[128:131]
    ds_read_b128 v[80:83], v25 offset:512
    v_mfma_f32_16x16x32_bf16 v[140:143], v[48:51], v[36:39], v[140:143]
    ds_read_b128 v[84:87], v25 offset:16896
    ds_read_b64_tr_b16 v[96:97], v16 offset:24576
    v_mfma_f32_16x16x32_bf16 v[132:135], v[52:55], v[32:35], v[132:135]
    ds_read_b64_tr_b16 v[98:99], v16 offset:26112
    v_mfma_f32_16x16x32_bf16 v[144:147], v[52:55], v[36:39], v[144:147]
    ds_read_b64_tr_b16 v[100:101], v17 offset:24576
    ds_read_b64_tr_b16 v[102:103], v17 offset:26112
    v_mfma_f32_16x16x32_bf16 v[136:139], v[56:59], v[32:35], v[136:139]
    ds_read_b64_tr_b16 v[104:105], v18 offset:24576
    v_mfma_f32_16x16x32_bf16 v[148:151], v[56:59], v[36:39], v[148:151]
    ds_read_b64_tr_b16 v[106:107], v18 offset:26112
    ds_read_b64_tr_b16 v[108:109], v16 offset:36864
    v_mfma_f32_16x16x32_bf16 v[152:155], v[60:63], v[32:35], v[152:155]
    ds_read_b64_tr_b16 v[110:111], v16 offset:38400
    v_mfma_f32_16x16x32_bf16 v[164:167], v[60:63], v[36:39], v[164:167]
    ds_read_b64_tr_b16 v[112:113], v17 offset:36864
    ds_read_b64_tr_b16 v[114:115], v17 offset:38400
    v_mfma_f32_16x16x32_bf16 v[156:159], v[64:67], v[32:35], v[156:159]
    ds_read_b64_tr_b16 v[116:117], v18 offset:36864
    v_mfma_f32_16x16x32_bf16 v[168:171], v[64:67], v[36:39], v[168:171]
    ds_read_b64_tr_b16 v[118:119], v18 offset:38400
    s_add_u32 m0, s25, 73728
    s_nop 0
    buffer_load_dwordx4 v8, s[12:15], s26 offen  lds
    v_mfma_f32_16x16x32_bf16 v[160:163], v[68:71], v[32:35], v[160:163]
    s_add_u32 m0, s25, 74752
    s_nop 0
    buffer_load_dwordx4 v9, s[12:15], s26 offen  lds
    v_mfma_f32_16x16x32_bf16 v[172:175], v[68:71], v[36:39], v[172:175]
    s_add_u32 m0, s25, 75776
    s_nop 0
    buffer_load_dwordx4 v10, s[12:15], s26 offen  lds
    s_add_u32 s26, s26, 88064
    s_waitcnt vmcnt(3) lgkmcnt(0)
    s_barrier
    v_mfma_f32_16x16x32_bf16 v[128:131], v[96:99], v[80:83], v[128:131]
    ds_read_b128 v[32:35], v26 offset:512
    ds_read_b128 v[36:39], v26 offset:16896
    ds_read_b64_tr_b16 v[48:49], v19 offset:0
    v_mfma_f32_16x16x32_bf16 v[140:143], v[96:99], v[84:87], v[140:143]
    ds_read_b64_tr_b16 v[50:51], v19 offset:1536
    ds_read_b64_tr_b16 v[52:53], v20 offset:0
    ds_read_b64_tr_b16 v[54:55], v20 offset:1536
    v_mfma_f32_16x16x32_bf16 v[132:135], v[100:103], v[80:83], v[132:135]
    ds_read_b64_tr_b16 v[56:57], v21 offset:0
    ds_read_b64_tr_b16 v[58:59], v21 offset:1536
    ds_read_b64_tr_b16 v[60:61], v19 offset:12288
    v_mfma_f32_16x16x32_bf16 v[144:147], v[100:103], v[84:87], v[144:147]
    ds_read_b64_tr_b16 v[62:63], v19 offset:13824
    ds_read_b64_tr_b16 v[64:65], v20 offset:12288
    ds_read_b64_tr_b16 v[66:67], v20 offset:13824
    ds_read_b64_tr_b16 v[68:69], v21 offset:12288
    v_mfma_f32_16x16x32_bf16 v[136:139], v[104:107], v[80:83], v[136:139]
    ds_read_b64_tr_b16 v[70:71], v21 offset:13824
    s_add_u32 m0, s25, 0
    s_nop 0
    buffer_load_dwordx4 v8, s[12:15], s26 offen  lds
    s_add_u32 m0, s25, 1024
    s_nop 0
    buffer_load_dwordx4 v9, s[12:15], s26 offen  lds
    v_mfma_f32_16x16x32_bf16 v[148:151], v[104:107], v[84:87], v[148:151]
    s_add_u32 m0, s25, 2048
    s_nop 0
    buffer_load_dwordx4 v10, s[12:15], s26 offen  lds
    s_add_u32 s26, s26, 88064
    v_lshlrev_b32 v212, 16, v204
    v_mfma_f32_16x16x32_bf16 v[152:155], v[108:111], v[80:83], v[152:155]
    v_and_b32 v213, 0xffff0000, v204
    v_fma_f32 v212, v212, v208, v209
    v_fma_f32 v213, v213, v208, v209
    v_mfma_f32_16x16x32_bf16 v[164:167], v[108:111], v[84:87], v[164:167]
    v_cvt_pk_bf16_f32 v204, v212, v213
    v_lshlrev_b32 v212, 16, v205
    v_and_b32 v213, 0xffff0000, v205
    v_fma_f32 v212, v212, v208, v209
    v_mfma_f32_16x16x32_bf16 v[156:159], v[112:115], v[80:83], v[156:159]
    v_fma_f32 v213, v213, v208, v209
    v_cvt_pk_bf16_f32 v205, v212, v213
    v_lshlrev_b32 v212, 16, v206
    v_mfma_f32_16x16x32_bf16 v[168:171], v[112:115], v[84:87], v[168:171]
    v_and_b32 v213, 0xffff0000, v206
    v_fma_f32 v212, v212, v208, v209
    v_fma_f32 v213, v213, v208, v209
    v_mfma_f32_16x16x32_bf16 v[160:163], v[116:119], v[80:83], v[160:163]
    v_cvt_pk_bf16_f32 v206, v212, v213
    v_lshlrev_b32 v212, 16, v207
    v_and_b32 v213, 0xffff0000, v207
    v_mfma_f32_16x16x32_bf16 v[172:175], v[116:119], v[84:87], v[172:175]
    v_fma_f32 v212, v212, v208, v209
    v_fma_f32 v213, v213, v208, v209
    v_cvt_pk_bf16_f32 v207, v212, v213
    ds_write_b128 v211, v[204:207] offset:768
    s_waitcnt vmcnt(3) lgkmcnt(0)
    s_barrier
    v_mfma_f32_16x16x32_bf16 v[128:131], v[48:51], v[32:35], v[128:131]
    ds_read_b128 v[80:83], v27 offset:512
    v_mfma_f32_16x16x32_bf16 v[140:143], v[48:51], v[36:39], v[140:143]
    ds_read_b128 v[84:87], v27 offset:16896
    ds_read_b64_tr_b16 v[96:97], v19 offset:24576
    v_mfma_f32_16x16x32_bf16 v[132:135], v[52:55], v[32:35], v[132:135]
    ds_read_b64_tr_b16 v[98:99], v19 offset:26112
    v_mfma_f32_16x16x32_bf16 v[144:147], v[52:55], v[36:39], v[144:147]
    ds_read_b64_tr_b16 v[100:101], v20 offset:24576
    ds_read_b64_tr_b16 v[102:103], v20 offset:26112
    v_mfma_f32_16x16x32_bf16 v[136:139], v[56:59], v[32:35], v[136:139]
    ds_read_b64_tr_b16 v[104:105], v21 offset:24576
    v_mfma_f32_16x16x32_bf16 v[148:151], v[56:59], v[36:39], v[148:151]
    ds_read_b64_tr_b16 v[106:107], v21 offset:26112
    ds_read_b64_tr_b16 v[108:109], v19 offset:36864
    v_mfma_f32_16x16x32_bf16 v[152:155], v[60:63], v[32:35], v[152:155]
    ds_read_b64_tr_b16 v[110:111], v19 offset:38400
    v_mfma_f32_16x16x32_bf16 v[164:167], v[60:63], v[36:39], v[164:167]
    ds_read_b64_tr_b16 v[112:113], v20 offset:36864
    ds_read_b64_tr_b16 v[114:115], v20 offset:38400
    v_mfma_f32_16x16x32_bf16 v[156:159], v[64:67], v[32:35], v[156:159]
    ds_read_b64_tr_b16 v[116:117], v21 offset:36864
    v_mfma_f32_16x16x32_bf16 v[168:171], v[64:67], v[36:39], v[168:171]
    ds_read_b64_tr_b16 v[118:119], v21 offset:38400
    s_add_u32 m0, s25, 24576
    s_nop 0
    buffer_load_dwordx4 v8, s[12:15], s26 offen  lds
    v_mfma_f32_16x16x32_bf16 v[160:163], v[68:71], v[32:35], v[160:163]
    s_add_u32 m0, s25, 25600
    s_nop 0
    buffer_load_dwordx4 v9, s[12:15], s26 offen  lds
    v_mfma_f32_16x16x32_bf16 v[172:175], v[68:71], v[36:39], v[172:175]
    s_add_u32 m0, s25, 26624
    s_nop 0
    buffer_load_dwordx4 v10, s[12:15], s26 offen  lds
    s_add_u32 s26, s26, 88064
    s_waitcnt vmcnt(3) lgkmcnt(0)
    s_barrier
    v_mfma_f32_16x16x32_bf16 v[128:131], v[96:99], v[80:83], v[128:131]
    ds_read_b128 v[32:35], v24 offset:768
    v_mfma_f32_16x16x32_bf16 v[140:143], v[96:99], v[84:87], v[140:143]
    ds_read_b128 v[36:39], v24 offset:17152
    ds_read_b64_tr_b16 v[48:49], v16 offset:0
    v_mfma_f32_16x16x32_bf16 v[132:135], v[100:103], v[80:83], v[132:135]
    ds_read_b64_tr_b16 v[50:51], v16 offset:1536
    v_mfma_f32_16x16x32_bf16 v[144:147], v[100:103], v[84:87], v[144:147]
    ds_read_b64_tr_b16 v[52:53], v17 offset:0
    ds_read_b64_tr_b16 v[54:55], v17 offset:1536
    v_mfma_f32_16x16x32_bf16 v[136:139], v[104:107], v[80:83], v[136:139]
    ds_read_b64_tr_b16 v[56:57], v18 offset:0
    v_mfma_f32_16x16x32_bf16 v[148:151], v[104:107], v[84:87], v[148:151]
    ds_read_b64_tr_b16 v[58:59], v18 offset:1536
    ds_read_b64_tr_b16 v[60:61], v16 offset:12288
    v_mfma_f32_16x16x32_bf16 v[152:155], v[108:111], v[80:83], v[152:155]
    ds_read_b64_tr_b16 v[62:63], v16 offset:13824
    v_mfma_f32_16x16x32_bf16 v[164:167], v[108:111], v[84:87], v[164:167]
    ds_read_b64_tr_b16 v[64:65], v17 offset:12288
    ds_read_b64_tr_b16 v[66:67], v17 offset:13824
    v_mfma_f32_16x16x32_bf16 v[156:159], v[112:115], v[80:83], v[156:159]
    ds_read_b64_tr_b16 v[68:69], v18 offset:12288
    v_mfma_f32_16x16x32_bf16 v[168:171], v[112:115], v[84:87], v[168:171]
    ds_read_b64_tr_b16 v[70:71], v18 offset:13824
    s_add_u32 m0, s25, 49152
    s_nop 0
    buffer_load_dwordx4 v8, s[12:15], s26 offen  lds
    v_mfma_f32_16x16x32_bf16 v[160:163], v[116:119], v[80:83], v[160:163]
    s_add_u32 m0, s25, 50176
    s_nop 0
    buffer_load_dwordx4 v9, s[12:15], s26 offen  lds
    v_mfma_f32_16x16x32_bf16 v[172:175], v[116:119], v[84:87], v[172:175]
    s_add_u32 m0, s25, 51200
    s_nop 0
    buffer_load_dwordx4 v10, s[12:15], s26 offen  lds
    s_add_u32 s26, s26, 88064
    s_waitcnt vmcnt(3) lgkmcnt(0)
    s_barrier
    v_mfma_f32_16x16x32_bf16 v[128:131], v[48:51], v[32:35], v[128:131]
    ds_read_b128 v[80:83], v25 offset:768
    v_mfma_f32_16x16x32_bf16 v[140:143], v[48:51], v[36:39], v[140:143]
    ds_read_b128 v[84:87], v25 offset:17152
    ds_read_b64_tr_b16 v[96:97], v16 offset:24576
    v_mfma_f32_16x16x32_bf16 v[132:135], v[52:55], v[32:35], v[132:135]
    ds_read_b64_tr_b16 v[98:99], v16 offset:26112
    v_mfma_f32_16x16x32_bf16 v[144:147], v[52:55], v[36:39], v[144:147]
    ds_read_b64_tr_b16 v[100:101], v17 offset:24576
    ds_read_b64_tr_b16 v[102:103], v17 offset:26112
    v_mfma_f32_16x16x32_bf16 v[136:139], v[56:59], v[32:35], v[136:139]
    ds_read_b64_tr_b16 v[104:105], v18 offset:24576
    v_mfma_f32_16x16x32_bf16 v[148:151], v[56:59], v[36:39], v[148:151]
    ds_read_b64_tr_b16 v[106:107], v18 offset:26112
    ds_read_b64_tr_b16 v[108:109], v16 offset:36864
    v_mfma_f32_16x16x32_bf16 v[152:155], v[60:63], v[32:35], v[152:155]
    ds_read_b64_tr_b16 v[110:111], v16 offset:38400
    v_mfma_f32_16x16x32_bf16 v[164:167], v[60:63], v[36:39], v[164:167]
    ds_read_b64_tr_b16 v[112:113], v17 offset:36864
    ds_read_b64_tr_b16 v[114:115], v17 offset:38400
    v_mfma_f32_16x16x32_bf16 v[156:159], v[64:67], v[32:35], v[156:159]
    ds_read_b64_tr_b16 v[116:117], v18 offset:36864
    v_mfma_f32_16x16x32_bf16 v[168:171], v[64:67], v[36:39], v[168:171]
    ds_read_b64_tr_b16 v[118:119], v18 offset:38400
    s_add_u32 m0, s25, 73728
    s_nop 0
    buffer_load_dwordx4 v8, s[12:15], s26 offen  lds
    v_mfma_f32_16x16x32_bf16 v[160:163], v[68:71], v[32:35], v[160:163]
    s_add_u32 m0, s25, 74752
    s_nop 0
    buffer_load_dwordx4 v9, s[12:15], s26 offen  lds
    v_mfma_f32_16x16x32_bf16 v[172:175], v[68:71], v[36:39], v[172:175]
    s_add_u32 m0, s25, 75776
    s_nop 0
    buffer_load_dwordx4 v10, s[12:15], s26 offen  lds
    s_add_u32 s26, s26, 88064
    s_waitcnt vmcnt(3) lgkmcnt(0)
    s_barrier
    v_mfma_f32_16x16x32_bf16 v[128:131], v[96:99], v[80:83], v[128:131]
    ds_read_b128 v[32:35], v26 offset:768
    v_mfma_f32_16x16x32_bf16 v[140:143], v[96:99], v[84:87], v[140:143]
    ds_read_b128 v[36:39], v26 offset:17152
    v_mfma_f32_16x16x32_bf16 v[132:135], v[100:103], v[80:83], v[132:135]
    ds_read_b64_tr_b16 v[48:49], v19 offset:0
    v_mfma_f32_16x16x32_bf16 v[144:147], v[100:103], v[84:87], v[144:147]
    ds_read_b64_tr_b16 v[50:51], v19 offset:1536
    v_mfma_f32_16x16x32_bf16 v[136:139], v[104:107], v[80:83], v[136:139]
    ds_read_b64_tr_b16 v[52:53], v20 offset:0
    v_mfma_f32_16x16x32_bf16 v[148:151], v[104:107], v[84:87], v[148:151]
    ds_read_b64_tr_b16 v[54:55], v20 offset:1536
    ds_read_b64_tr_b16 v[56:57], v21 offset:0
    v_mfma_f32_16x16x32_bf16 v[152:155], v[108:111], v[80:83], v[152:155]
    ds_read_b64_tr_b16 v[58:59], v21 offset:1536
    v_mfma_f32_16x16x32_bf16 v[164:167], v[108:111], v[84:87], v[164:167]
    ds_read_b64_tr_b16 v[60:61], v19 offset:12288
    v_mfma_f32_16x16x32_bf16 v[156:159], v[112:115], v[80:83], v[156:159]
    ds_read_b64_tr_b16 v[62:63], v19 offset:13824
    v_mfma_f32_16x16x32_bf16 v[168:171], v[112:115], v[84:87], v[168:171]
    ds_read_b64_tr_b16 v[64:65], v20 offset:12288
    v_mfma_f32_16x16x32_bf16 v[160:163], v[116:119], v[80:83], v[160:163]
    ds_read_b64_tr_b16 v[66:67], v20 offset:13824
    v_mfma_f32_16x16x32_bf16 v[172:175], v[116:119], v[84:87], v[172:175]
    ds_read_b64_tr_b16 v[68:69], v21 offset:12288
    ds_read_b64_tr_b16 v[70:71], v21 offset:13824
    s_waitcnt vmcnt(0) lgkmcnt(0)
    s_barrier
    v_mfma_f32_16x16x32_bf16 v[128:131], v[48:51], v[32:35], v[128:131]
    ds_read_b128 v[80:83], v27 offset:768
    v_mfma_f32_16x16x32_bf16 v[140:143], v[48:51], v[36:39], v[140:143]
    ds_read_b128 v[84:87], v27 offset:17152
    v_mfma_f32_16x16x32_bf16 v[132:135], v[52:55], v[32:35], v[132:135]
    ds_read_b64_tr_b16 v[96:97], v19 offset:24576
    v_mfma_f32_16x16x32_bf16 v[144:147], v[52:55], v[36:39], v[144:147]
    ds_read_b64_tr_b16 v[98:99], v19 offset:26112
    v_mfma_f32_16x16x32_bf16 v[136:139], v[56:59], v[32:35], v[136:139]
    ds_read_b64_tr_b16 v[100:101], v20 offset:24576
    v_mfma_f32_16x16x32_bf16 v[148:151], v[56:59], v[36:39], v[148:151]
    ds_read_b64_tr_b16 v[102:103], v20 offset:26112
    ds_read_b64_tr_b16 v[104:105], v21 offset:24576
    v_mfma_f32_16x16x32_bf16 v[152:155], v[60:63], v[32:35], v[152:155]
    ds_read_b64_tr_b16 v[106:107], v21 offset:26112
    v_mfma_f32_16x16x32_bf16 v[164:167], v[60:63], v[36:39], v[164:167]
    ds_read_b64_tr_b16 v[108:109], v19 offset:36864
    v_mfma_f32_16x16x32_bf16 v[156:159], v[64:67], v[32:35], v[156:159]
    ds_read_b64_tr_b16 v[110:111], v19 offset:38400
    v_mfma_f32_16x16x32_bf16 v[168:171], v[64:67], v[36:39], v[168:171]
    ds_read_b64_tr_b16 v[112:113], v20 offset:36864
    v_mfma_f32_16x16x32_bf16 v[160:163], v[68:71], v[32:35], v[160:163]
    ds_read_b64_tr_b16 v[114:115], v20 offset:38400
    v_mfma_f32_16x16x32_bf16 v[172:175], v[68:71], v[36:39], v[172:175]
    ds_read_b64_tr_b16 v[116:117], v21 offset:36864
    ds_read_b64_tr_b16 v[118:119], v21 offset:38400
    s_waitcnt lgkmcnt(0)
    v_mfma_f32_16x16x32_bf16 v[128:131], v[96:99], v[80:83], v[128:131]
    v_mfma_f32_16x16x32_bf16 v[140:143], v[96:99], v[84:87], v[140:143]
    v_mfma_f32_16x16x32_bf16 v[132:135], v[100:103], v[80:83], v[132:135]
    v_mfma_f32_16x16x32_bf16 v[144:147], v[100:103], v[84:87], v[144:147]
    v_mfma_f32_16x16x32_bf16 v[136:139], v[104:107], v[80:83], v[136:139]
    v_mfma_f32_16x16x32_bf16 v[148:151], v[104:107], v[84:87], v[148:151]
    v_mfma_f32_16x16x32_bf16 v[152:155], v[108:111], v[80:83], v[152:155]
    v_mfma_f32_16x16x32_bf16 v[164:167], v[108:111], v[84:87], v[164:167]
    v_mfma_f32_16x16x32_bf16 v[156:159], v[112:115], v[80:83], v[156:159]
    v_mfma_f32_16x16x32_bf16 v[168:171], v[112:115], v[84:87], v[168:171]
    v_mfma_f32_16x16x32_bf16 v[160:163], v[116:119], v[80:83], v[160:163]
    v_mfma_f32_16x16x32_bf16 v[172:175], v[116:119], v[84:87], v[172:175]
    s_barrier
    v_lshlrev_b32 v6, 5, v4
    v_lshl_add_u32 v6, v5, 3, v6
    s_lshl_b32 s27, s22, 6
    s_lshl_b32 s28, s23, 5
    s_add_u32 s27, s27, s28
    v_add_u32 v7, s27, v4
    s_mov_b32 s27, 2752
    v_mul_lo_u32 v7, v7, s27
    v_lshl_add_u32 v7, v5, 3, v7
    s_mul_i32 s29, s21, 12
    s_mul_i32 s27, s24, 3
    s_add_u32 s29, s29, s27
    s_mov_b32 s30, 0xbfb8aa3b
    s_nop 4
    s_add_u32 s27, s29, 0
    s_cmp_ge_u32 s27, 86
    s_cbranch_scc1 k_gu_kernel_skip0
    s_lshl_b32 s27, s27, 5
    v_mul_f32 v32, s30, v128
    v_mul_f32 v33, s30, v129
    v_mul_f32 v34, s30, v130
    v_mul_f32 v35, s30, v131
    v_exp_f32 v32, v32
    v_exp_f32 v33, v33
    v_exp_f32 v34, v34
    v_exp_f32 v35, v35
    s_nop 0
    v_add_f32 v32, 1.0, v32
    v_add_f32 v33, 1.0, v33
    v_add_f32 v34, 1.0, v34
    v_add_f32 v35, 1.0, v35
    v_rcp_f32 v32, v32
    v_rcp_f32 v33, v33
    v_rcp_f32 v34, v34
    v_rcp_f32 v35, v35
    s_nop 0
    v_mul_f32 v32, v32, v152
    v_mul_f32 v33, v33, v153
    v_mul_f32 v34, v34, v154
    v_mul_f32 v35, v35, v155
    v_cvt_pk_bf16_f32 v36, v32, v33
    v_cvt_pk_bf16_f32 v37, v34, v35
    buffer_store_dwordx2 v[36:37], v7, s[16:19], s27 offen offset:0
    v_add_u32 v41, 44032, v7
    v_mul_f32 v32, s30, v140
    v_mul_f32 v33, s30, v141
    v_mul_f32 v34, s30, v142
    v_mul_f32 v35, s30, v143
    v_exp_f32 v32, v32
    v_exp_f32 v33, v33
    v_exp_f32 v34, v34
    v_exp_f32 v35, v35
    s_nop 0
    v_add_f32 v32, 1.0, v32
    v_add_f32 v33, 1.0, v33
    v_add_f32 v34, 1.0, v34
    v_add_f32 v35, 1.0, v35
    v_rcp_f32 v32, v32
    v_rcp_f32 v33, v33
    v_rcp_f32 v34, v34
    v_rcp_f32 v35, v35
    s_nop 0
    v_mul_f32 v32, v32, v164
    v_mul_f32 v33, v33, v165
    v_mul_f32 v34, v34, v166
    v_mul_f32 v35, v35, v167
    v_cvt_pk_bf16_f32 v38, v32, v33
    v_cvt_pk_bf16_f32 v39, v34, v35
    buffer_store_dwordx2 v[38:39], v41, s[16:19], s27 offen
    s_nop 1
k_gu_kernel_skip0:
    s_add_u32 s27, s29, 1
    s_cmp_ge_u32 s27, 86
    s_cbranch_scc1 k_gu_kernel_skip1
    s_lshl_b32 s27, s27, 5
    v_mul_f32 v32, s30, v132
    v_mul_f32 v33, s30, v133
    v_mul_f32 v34, s30, v134
    v_mul_f32 v35, s30, v135
    v_exp_f32 v32, v32
    v_exp_f32 v33, v33
    v_exp_f32 v34, v34
    v_exp_f32 v35, v35
    s_nop 0
    v_add_f32 v32, 1.0, v32
    v_add_f32 v33, 1.0, v33
    v_add_f32 v34, 1.0, v34
    v_add_f32 v35, 1.0, v35
    v_rcp_f32 v32, v32
    v_rcp_f32 v33, v33
    v_rcp_f32 v34, v34
    v_rcp_f32 v35, v35
    s_nop 0
    v_mul_f32 v32, v32, v156
    v_mul_f32 v33, v33, v157
    v_mul_f32 v34, v34, v158
    v_mul_f32 v35, v35, v159
    v_cvt_pk_bf16_f32 v36, v32, v33
    v_cvt_pk_bf16_f32 v37, v34, v35
    buffer_store_dwordx2 v[36:37], v7, s[16:19], s27 offen offset:0
    v_add_u32 v41, 44032, v7
    v_mul_f32 v32, s30, v144
    v_mul_f32 v33, s30, v145
    v_mul_f32 v34, s30, v146
    v_mul_f32 v35, s30, v147
    v_exp_f32 v32, v32
    v_exp_f32 v33, v33
    v_exp_f32 v34, v34
    v_exp_f32 v35, v35
    s_nop 0
    v_add_f32 v32, 1.0, v32
    v_add_f32 v33, 1.0, v33
    v_add_f32 v34, 1.0, v34
    v_add_f32 v35, 1.0, v35
    v_rcp_f32 v32, v32
    v_rcp_f32 v33, v33
    v_rcp_f32 v34, v34
    v_rcp_f32 v35, v35
    s_nop 0
    v_mul_f32 v32, v32, v168
    v_mul_f32 v33, v33, v169
    v_mul_f32 v34, v34, v170
    v_mul_f32 v35, v35, v171
    v_cvt_pk_bf16_f32 v38, v32, v33
    v_cvt_pk_bf16_f32 v39, v34, v35
    buffer_store_dwordx2 v[38:39], v41, s[16:19], s27 offen
    s_nop 1
k_gu_kernel_skip1:
    s_add_u32 s27, s29, 2
    s_cmp_ge_u32 s27, 86
    s_cbranch_scc1 k_gu_kernel_skip2
    s_lshl_b32 s27, s27, 5
    v_mul_f32 v32, s30, v136
    v_mul_f32 v33, s30, v137
    v_mul_f32 v34, s30, v138
    v_mul_f32 v35, s30, v139
    v_exp_f32 v32, v32
    v_exp_f32 v33, v33
    v_exp_f32 v34, v34
    v_exp_f32 v35, v35
    s_nop 0
    v_add_f32 v32, 1.0, v32
    v_add_f32 v33, 1.0, v33
    v_add_f32 v34, 1.0, v34
    v_add_f32 v35, 1.0, v35
    v_rcp_f32 v32, v32
    v_rcp_f32 v33, v33
    v_rcp_f32 v34, v34
    v_rcp_f32 v35, v35
    s_nop 0
    v_mul_f32 v32, v32, v160
    v_mul_f32 v33, v33, v161
    v_mul_f32 v34, v34, v162
    v_mul_f32 v35, v35, v163
    v_cvt_pk_bf16_f32 v36, v32, v33
    v_cvt_pk_bf16_f32 v37, v34, v35
    buffer_store_dwordx2 v[36:37], v7, s[16:19], s27 offen offset:0
    v_add_u32 v41, 44032, v7
    v_mul_f32 v32, s30, v148
    v_mul_f32 v33, s30, v149
    v_mul_f32 v34, s30, v150
    v_mul_f32 v35, s30, v151
    v_exp_f32 v32, v32
    v_exp_f32 v33, v33
    v_exp_f32 v34, v34
    v_exp_f32 v35, v35
    s_nop 0
    v_add_f32 v32, 1.0, v32
    v_add_f32 v33, 1.0, v33
    v_add_f32 v34, 1.0, v34
    v_add_f32 v35, 1.0, v35
    v_rcp_f32 v32, v32
    v_rcp_f32 v33, v33
    v_rcp_f32 v34, v34
    v_rcp_f32 v35, v35
    s_nop 0
    v_mul_f32 v32, v32, v172
    v_mul_f32 v33, v33, v173
    v_mul_f32 v34, v34, v174
    v_mul_f32 v35, v35, v175
    v_cvt_pk_bf16_f32 v38, v32, v33
    v_cvt_pk_bf16_f32 v39, v34, v35
    buffer_store_dwordx2 v[38:39], v41, s[16:19], s27 offen
    s_nop 1
k_gu_kernel_skip2:
k_gu_kernel_done:
    s_endpgm
.text
.globl k_down_kernel
.p2align 8
.type k_down_kernel,@function
k_down_kernel:
    s_cmp_ge_u32 s2, 256
    s_cbranch_scc1 k_down_kernel_done
    s_load_dwordx2 s[32:33], s[0:1], 0
    s_load_dwordx2 s[34:35], s[0:1], 48
    s_load_dwordx2 s[36:37], s[0:1], 56
    s_load_dwordx2 s[40:41], s[0:1], 72
    v_lshrrev_b32 v1, 6, v0
    v_and_b32 v2, 63, v0
    s_nop 0
    v_readfirstlane_b32 s20, v1
    s_and_b32 s22, s2, 3
    s_lshl_b32 s22, s22, 3
    s_bfe_u32 s21, s2, 0x30003
    s_add_u32 s22, s22, s21
    s_bfe_u32 s21, s2, 0x10002
    s_lshl_b32 s21, s21, 2
    s_lshr_b32 s100, s2, 6
    s_add_u32 s21, s21, s100
    s_lshr_b32 s23, s20, 2
    s_and_b32 s24, s20, 3
    s_waitcnt lgkmcnt(0)
    s_add_u32 s8, s40, 10485760
    s_addc_u32 s9, s41, 0
    s_mov_b32 s10, 5636096
    s_mov_b32 s11, 0x00020000
    s_mov_b32 s12, s34
    s_mov_b32 s13, s35
    s_mov_b32 s14, 1409024
    s_mov_b32 s15, 0x00020000
    s_add_u32 s16, s40, 8388608
    s_addc_u32 s17, s41, 0
    s_mov_b32 s18, 2097152
    s_mov_b32 s19, 0x00020000
    s_mov_b32 s44, s36
    s_mov_b32 s45, s37
    s_mov_b32 s46, 2097152
    s_mov_b32 s47, 0x00020000
    s_lshl_b32 s28, s20, 7
    v_add_u32 v12, s28, v2
    v_lshrrev_b32 v13, 4, v12
    v_and_b32 v14, 15, v12
    v_and_b32 v15, 15, v13
    v_xor_b32 v14, v14, v15
    s_mov_b32 s28, 2752
    v_mul_lo_u32 v13, v13, s28
    v_lshl_add_u32 v8, v14, 4, v13
    v_lshrrev_b32 v13, 3, v12
    v_and_b32 v14, 7, v12
    v_bfe_u32 v15, v13, 1, 1
    v_bfe_u32 v16, v13, 3, 1
    v_lshl_or_b32 v15, v16, 1, v15
    v_lshlrev_b32 v15, 1, v15
    v_xor_b32 v14, v14, v15
    v_lshlrev_b32 v13, 10, v13
    v_lshl_add_u32 v10, v14, 4, v13
    s_lshl_b32 s28, s20, 7
    v_add_u32 v12, s28, v2
    v_add_u32 v12, 64, v12
    v_lshrrev_b32 v13, 4, v12
    v_and_b32 v14, 15, v12
    v_and_b32 v15, 15, v13
    v_xor_b32 v14, v14, v15
    s_mov_b32 s28, 2752
    v_mul_lo_u32 v13, v13, s28
    v_lshl_add_u32 v9, v14, 4, v13
    v_lshrrev_b32 v13, 3, v12
    v_and_b32 v14, 7, v12
    v_bfe_u32 v15, v13, 1, 1
    v_bfe_u32 v16, v13, 3, 1
    v_lshl_or_b32 v15, v16, 1, v15
    v_lshlrev_b32 v15, 1, v15
    v_xor_b32 v14, v14, v15
    v_lshlrev_b32 v13, 10, v13
    v_lshl_add_u32 v11, v14, 4, v13
    s_mul_i32 s26, s22, 176128
    s_lshl_b32 s27, s21, 7
    s_lshl_b32 s25, s20, 11
    s_add_u32 m0, s25, 0
    s_nop 0
    buffer_load_dwordx4 v8, s[8:11], s26 offen  lds
    s_add_u32 m0, s25, 16384
    s_nop 0
    buffer_load_dwordx4 v10, s[12:15], s27 offen  lds
    s_add_u32 m0, s25, 1024
    s_nop 0
    buffer_load_dwordx4 v9, s[8:11], s26 offen  lds
    s_add_u32 m0, s25, 17408
    s_nop 0
    buffer_load_dwordx4 v11, s[12:15], s27 offen  lds
    s_add_u32 s26, s26, 256
    s_add_u32 s27, s27, 131072
    s_add_u32 m0, s25, 32768
    s_nop 0
    buffer_load_dwordx4 v8, s[8:11], s26 offen  lds
    s_add_u32 m0, s25, 49152
    s_nop 0
    buffer_load_dwordx4 v10, s[12:15], s27 offen  lds
    s_add_u32 m0, s25, 33792
    s_nop 0
    buffer_load_dwordx4 v9, s[8:11], s26 offen  lds
    s_add_u32 m0, s25, 50176
    s_nop 0
    buffer_load_dwordx4 v11, s[12:15], s27 offen  lds
    s_add_u32 s26, s26, 256
    s_add_u32 s27, s27, 131072
    v_and_b32 v4, 15, v2
    v_lshrrev_b32 v5, 4, v2
    v_lshl_add_u32 v140, v2, 4, s25
    v_add_u32 v141, 65536, v140
    s_lshl_b32 s28, s22, 6
    s_lshl_b32 s29, s23, 5
    s_add_u32 s28, s28, s29
    v_add_u32 v6, s28, v4
    v_lshlrev_b32 v6, 10, v6
    v_lshl_add_u32 v6, v5, 3, v6
    s_lshl_b32 s28, s21, 7
    s_lshl_b32 s29, s24, 5
    s_add_u32 s30, s28, s29
    v_add_u32 v7, 16384, v6
    buffer_load_dwordx2 v[136:137], v6, s[16:19], s30 offen
    buffer_load_dwordx2 v[138:139], v7, s[16:19], s30 offen
    s_lshl_b32 s28, s23, 13
    v_lshlrev_b32 v12, 8, v4
    v_add_u32 v12, s28, v12
    v_and_b32 v13, 3, v4
    v_xor_b32 v13, v13, v5
    v_lshrrev_b32 v14, 2, v4
    v_xor_b32 v15, 0, v14
    v_lshl_or_b32 v15, v15, 2, v13
    v_lshl_add_u32 v16, v15, 4, v12
    v_add_u32 v20, 65536, v16
    v_xor_b32 v15, 1, v14
    v_lshl_or_b32 v15, v15, 2, v13
    v_lshl_add_u32 v17, v15, 4, v12
    v_add_u32 v21, 65536, v17
    v_xor_b32 v15, 2, v14
    v_lshl_or_b32 v15, v15, 2, v13
    v_lshl_add_u32 v18, v15, 4, v12
    v_add_u32 v22, 65536, v18
    v_xor_b32 v15, 3, v14
    v_lshl_or_b32 v15, v15, 2, v13
    v_lshl_add_u32 v19, v15, 4, v12
    v_add_u32 v23, 65536, v19
    v_lshrrev_b32 v12, 2, v4
    v_and_b32 v13, 3, v4
    v_lshl_add_u32 v14, v5, 3, v12
    v_lshlrev_b32 v14, 7, v14
    v_lshl_add_u32 v14, v13, 3, v14
    v_lshrrev_b32 v15, 1, v12
    v_and_b32 v13, 1, v5
    v_lshl_or_b32 v15, v13, 1, v15
    v_xor_b32 v15, s24, v15
    v_lshl_add_u32 v24, v15, 5, v14
    v_add_u32 v24, 16384, v24
    v_add_u32 v25, 65536, v24
    v_mov_b32 v128, 0
    v_mov_b32 v129, 0
    v_mov_b32 v130, 0
    v_mov_b32 v131, 0
    v_mov_b32 v132, 0
    v_mov_b32 v133, 0
    v_mov_b32 v134, 0
    v_mov_b32 v135, 0
    s_waitcnt vmcnt(6) lgkmcnt(0)
    s_barrier
    ds_read_b128 v[28:31], v16 offset:0
    ds_read_b128 v[32:35], v16 offset:4096
    ds_read_b64_tr_b16 v[60:61], v24 offset:0
    ds_read_b64_tr_b16 v[62:63], v24 offset:512
    ds_read_b128 v[36:39], v17 offset:0
    ds_read_b128 v[40:43], v17 offset:4096
    ds_read_b64_tr_b16 v[64:65], v24 offset:4096
    ds_read_b64_tr_b16 v[66:67], v24 offset:4608
    ds_read_b128 v[44:47], v18 offset:0
    ds_read_b128 v[48:51], v18 offset:4096
    ds_read_b64_tr_b16 v[68:69], v24 offset:8192
    ds_read_b64_tr_b16 v[70:71], v24 offset:8704
    ds_read_b128 v[52:55], v19 offset:0
    ds_read_b128 v[56:59], v19 offset:4096
    ds_read_b64_tr_b16 v[72:73], v24 offset:12288
    ds_read_b64_tr_b16 v[74:75], v24 offset:12800
    s_add_u32 m0, s25, 65536
    s_nop 0
    buffer_load_dwordx4 v8, s[8:11], s26 offen  lds
    s_add_u32 m0, s25, 81920
    s_nop 0
    buffer_load_dwordx4 v10, s[12:15], s27 offen  lds
    s_add_u32 m0, s25, 66560
    s_nop 0
    buffer_load_dwordx4 v9, s[8:11], s26 offen  lds
    s_add_u32 m0, s25, 82944
    s_nop 0
    buffer_load_dwordx4 v11, s[12:15], s27 offen  lds
    s_add_u32 s26, s26, 256
    s_add_u32 s27, s27, 131072
    s_waitcnt vmcnt(6) lgkmcnt(0)
    s_barrier
    v_mfma_f32_16x16x32_bf16 v[128:131], v[60:63], v[28:31], v[128:131]
    ds_read_b128 v[76:79], v16 offset:32768
    ds_read_b128 v[80:83], v16 offset:36864
    v_mfma_f32_16x16x32_bf16 v[132:135], v[60:63], v[32:35], v[132:135]
    ds_read_b64_tr_b16 v[108:109], v24 offset:32768
    ds_read_b64_tr_b16 v[110:111], v24 offset:33280
    ds_read_b128 v[84:87], v17 offset:32768
    v_mfma_f32_16x16x32_bf16 v[128:131], v[64:67], v[36:39], v[128:131]
    ds_read_b128 v[88:91], v17 offset:36864
    ds_read_b64_tr_b16 v[112:113], v24 offset:36864
    ds_read_b64_tr_b16 v[114:115], v24 offset:37376
    v_mfma_f32_16x16x32_bf16 v[132:135], v[64:67], v[40:43], v[132:135]
    ds_read_b128 v[92:95], v18 offset:32768
    ds_read_b128 v[96:99], v18 offset:36864
    ds_read_b64_tr_b16 v[116:117], v24 offset:40960
    v_mfma_f32_16x16x32_bf16 v[128:131], v[68:71], v[44:47], v[128:131]
    ds_read_b64_tr_b16 v[118:119], v24 offset:41472
    ds_read_b128 v[100:103], v19 offset:32768
    v_mfma_f32_16x16x32_bf16 v[132:135], v[68:71], v[48:51], v[132:135]
    ds_read_b128 v[104:107], v19 offset:36864
    ds_read_b64_tr_b16 v[120:121], v24 offset:45056
    ds_read_b64_tr_b16 v[122:123], v24 offset:45568
    v_mfma_f32_16x16x32_bf16 v[128:131], v[72:75], v[52:55], v[128:131]
    s_add_u32 m0, s25, 98304
    s_nop 0
    buffer_load_dwordx4 v8, s[8:11], s26 offen  lds
    s_add_u32 m0, s25, 114688
    s_nop 0
    buffer_load_dwordx4 v10, s[12:15], s27 offen  lds
    s_add_u32 m0, s25, 99328
    s_nop 0
    buffer_load_dwordx4 v9, s[8:11], s26 offen  lds
    v_mfma_f32_16x16x32_bf16 v[132:135], v[72:75], v[56:59], v[132:135]
    s_add_u32 m0, s25, 115712
    s_nop 0
    buffer_load_dwordx4 v11, s[12:15], s27 offen  lds
    s_add_u32 s26, s26, 256
    s_add_u32 s27, s27, 131072
    s_waitcnt vmcnt(4) lgkmcnt(0)
    s_barrier
    v_mfma_f32_16x16x32_bf16 v[128:131], v[108:111], v[76:79], v[128:131]
    ds_read_b128 v[28:31], v20 offset:0
    ds_read_b128 v[32:35], v20 offset:4096
    v_mfma_f32_16x16x32_bf16 v[132:135], v[108:111], v[80:83], v[132:135]
    ds_read_b64_tr_b16 v[60:61], v25 offset:0
    ds_read_b64_tr_b16 v[62:63], v25 offset:512
    ds_read_b128 v[36:39], v21 offset:0
    v_mfma_f32_16x16x32_bf16 v[128:131], v[112:115], v[84:87], v[128:131]
    ds_read_b128 v[40:43], v21 offset:4096
    ds_read_b64_tr_b16 v[64:65], v25 offset:4096
    ds_read_b64_tr_b16 v[66:67], v25 offset:4608
    v_mfma_f32_16x16x32_bf16 v[132:135], v[112:115], v[88:91], v[132:135]
    ds_read_b128 v[44:47], v22 offset:0
    ds_read_b128 v[48:51], v22 offset:4096
    ds_read_b64_tr_b16 v[68:69], v25 offset:8192
    v_mfma_f32_16x16x32_bf16 v[128:131], v[116:119], v[92:95], v[128:131]
    ds_read_b64_tr_b16 v[70:71], v25 offset:8704
    ds_read_b128 v[52:55], v23 offset:0
    v_mfma_f32_16x16x32_bf16 v[132:135], v[116:119], v[96:99], v[132:135]
    ds_read_b128 v[56:59], v23 offset:4096
    ds_read_b64_tr_b16 v[72:73], v25 offset:12288
    ds_read_b64_tr_b16 v[74:75], v25 offset:12800
    v_mfma_f32_16x16x32_bf16 v[128:131], v[120:123], v[100:103], v[128:131]
    s_add_u32 m0, s25, 0
    s_nop 0
    buffer_load_dwordx4 v8, s[8:11], s26 offen  lds
    s_add_u32 m0, s25, 16384
    s_nop 0
    buffer_load_dwordx4 v10, s[12:15], s27 offen  lds
    s_add_u32 m0, s25, 1024
    s_nop 0
    buffer_load_dwordx4 v9, s[8:11], s26 offen  lds
    v_mfma_f32_16x16x32_bf16 v[132:135], v[120:123], v[104:107], v[132:135]
    s_add_u32 m0, s25, 17408
    s_nop 0
    buffer_load_dwordx4 v11, s[12:15], s27 offen  lds
    s_add_u32 s26, s26, 256
    s_add_u32 s27, s27, 131072
    s_waitcnt vmcnt(4) lgkmcnt(0)
    s_barrier
    v_mfma_f32_16x16x32_bf16 v[128:131], v[60:63], v[28:31], v[128:131]
    ds_read_b128 v[76:79], v20 offset:32768
    ds_read_b128 v[80:83], v20 offset:36864
    v_mfma_f32_16x16x32_bf16 v[132:135], v[60:63], v[32:35], v[132:135]
    ds_read_b64_tr_b16 v[108:109], v25 offset:32768
    ds_read_b64_tr_b16 v[110:111], v25 offset:33280
    ds_read_b128 v[84:87], v21 offset:32768
    v_mfma_f32_16x16x32_bf16 v[128:131], v[64:67], v[36:39], v[128:131]
    ds_read_b128 v[88:91], v21 offset:36864
    ds_read_b64_tr_b16 v[112:113], v25 offset:36864
    ds_read_b64_tr_b16 v[114:115], v25 offset:37376
    v_mfma_f32_16x16x32_bf16 v[132:135], v[64:67], v[40:43], v[132:135]
    ds_read_b128 v[92:95], v22 offset:32768
    ds_read_b128 v[96:99], v22 offset:36864
    ds_read_b64_tr_b16 v[116:117], v25 offset:40960
    v_mfma_f32_16x16x32_bf16 v[128:131], v[68:71], v[44:47], v[128:131]
    ds_read_b64_tr_b16 v[118:119], v25 offset:41472
    ds_read_b128 v[100:103], v23 offset:32768
    v_mfma_f32_16x16x32_bf16 v[132:135], v[68:71], v[48:51], v[132:135]
    ds_read_b128 v[104:107], v23 offset:36864
    ds_read_b64_tr_b16 v[120:121], v25 offset:45056
    ds_read_b64_tr_b16 v[122:123], v25 offset:45568
    v_mfma_f32_16x16x32_bf16 v[128:131], v[72:75], v[52:55], v[128:131]
    s_add_u32 m0, s25, 32768
    s_nop 0
    buffer_load_dwordx4 v8, s[8:11], s26 offen  lds
    s_add_u32 m0, s25, 49152
    s_nop 0
    buffer_load_dwordx4 v10, s[12:15], s27 offen  lds
    s_add_u32 m0, s25, 33792
    s_nop 0
    buffer_load_dwordx4 v9, s[8:11], s26 offen  lds
    v_mfma_f32_16x16x32_bf16 v[132:135], v[72:75], v[56:59], v[132:135]
    s_add_u32 m0, s25, 50176
    s_nop 0
    buffer_load_dwordx4 v11, s[12:15], s27 offen  lds
    s_add_u32 s26, s26, 256
    s_add_u32 s27, s27, 131072
    s_waitcnt vmcnt(4) lgkmcnt(0)
    s_barrier
    v_mfma_f32_16x16x32_bf16 v[128:131], v[108:111], v[76:79], v[128:131]
    ds_read_b128 v[28:31], v16 offset:0
    ds_read_b128 v[32:35], v16 offset:4096
    v_mfma_f32_16x16x32_bf16 v[132:135], v[108:111], v[80:83], v[132:135]
    ds_read_b64_tr_b16 v[60:61], v24 offset:0
    ds_read_b64_tr_b16 v[62:63], v24 offset:512
    ds_read_b128 v[36:39], v17 offset:0
    v_mfma_f32_16x16x32_bf16 v[128:131], v[112:115], v[84:87], v[128:131]
    ds_read_b128 v[40:43], v17 offset:4096
    ds_read_b64_tr_b16 v[64:65], v24 offset:4096
    ds_read_b64_tr_b16 v[66:67], v24 offset:4608
    v_mfma_f32_16x16x32_bf16 v[132:135], v[112:115], v[88:91], v[132:135]
    ds_read_b128 v[44:47], v18 offset:0
    ds_read_b128 v[48:51], v18 offset:4096
    ds_read_b64_tr_b16 v[68:69], v24 offset:8192
    v_mfma_f32_16x16x32_bf16 v[128:131], v[116:119], v[92:95], v[128:131]
    ds_read_b64_tr_b16 v[70:71], v24 offset:8704
    ds_read_b128 v[52:55], v19 offset:0
    v_mfma_f32_16x16x32_bf16 v[132:135], v[116:119], v[96:99], v[132:135]
    ds_read_b128 v[56:59], v19 offset:4096
    ds_read_b64_tr_b16 v[72:73], v24 offset:12288
    ds_read_b64_tr_b16 v[74:75], v24 offset:12800
    v_mfma_f32_16x16x32_bf16 v[128:131], v[120:123], v[100:103], v[128:131]
    s_add_u32 m0, s25, 65536
    s_nop 0
    buffer_load_dwordx4 v8, s[8:11], s26 offen  lds
    s_add_u32 m0, s25, 81920
    s_nop 0
    buffer_load_dwordx4 v10, s[12:15], s27 offen  lds
    s_add_u32 m0, s25, 66560
    s_nop 0
    buffer_load_dwordx4 v9, s[8:11], s26 offen  lds
    v_mfma_f32_16x16x32_bf16 v[132:135], v[120:123], v[104:107], v[132:135]
    s_add_u32 m0, s25, 82944
    s_nop 0
    buffer_load_dwordx4 v11, s[12:15], s27 offen  lds
    s_add_u32 s26, s26, 256
    s_add_u32 s27, s27, 131072
    s_waitcnt vmcnt(4) lgkmcnt(0)
    s_barrier
    v_mfma_f32_16x16x32_bf16 v[128:131], v[60:63], v[28:31], v[128:131]
    ds_read_b128 v[76:79], v16 offset:32768
    ds_read_b128 v[80:83], v16 offset:36864
    v_mfma_f32_16x16x32_bf16 v[132:135], v[60:63], v[32:35], v[132:135]
    ds_read_b64_tr_b16 v[108:109], v24 offset:32768
    ds_read_b64_tr_b16 v[110:111], v24 offset:33280
    ds_read_b128 v[84:87], v17 offset:32768
    v_mfma_f32_16x16x32_bf16 v[128:131], v[64:67], v[36:39], v[128:131]
    ds_read_b128 v[88:91], v17 offset:36864
    ds_read_b64_tr_b16 v[112:113], v24 offset:36864
    ds_read_b64_tr_b16 v[114:115], v24 offset:37376
    v_mfma_f32_16x16x32_bf16 v[132:135], v[64:67], v[40:43], v[132:135]
    ds_read_b128 v[92:95], v18 offset:32768
    ds_read_b128 v[96:99], v18 offset:36864
    ds_read_b64_tr_b16 v[116:117], v24 offset:40960
    v_mfma_f32_16x16x32_bf16 v[128:131], v[68:71], v[44:47], v[128:131]
    ds_read_b64_tr_b16 v[118:119], v24 offset:41472
    ds_read_b128 v[100:103], v19 offset:32768
    v_mfma_f32_16x16x32_bf16 v[132:135], v[68:71], v[48:51], v[132:135]
    ds_read_b128 v[104:107], v19 offset:36864
    ds_read_b64_tr_b16 v[120:121], v24 offset:45056
    ds_read_b64_tr_b16 v[122:123], v24 offset:45568
    v_mfma_f32_16x16x32_bf16 v[128:131], v[72:75], v[52:55], v[128:131]
    s_add_u32 m0, s25, 98304
    s_nop 0
    buffer_load_dwordx4 v8, s[8:11], s26 offen  lds
    s_add_u32 m0, s25, 114688
    s_nop 0
    buffer_load_dwordx4 v10, s[12:15], s27 offen  lds
    s_add_u32 m0, s25, 99328
    s_nop 0
    buffer_load_dwordx4 v9, s[8:11], s26 offen  lds
    v_mfma_f32_16x16x32_bf16 v[132:135], v[72:75], v[56:59], v[132:135]
    s_add_u32 m0, s25, 115712
    s_nop 0
    buffer_load_dwordx4 v11, s[12:15], s27 offen  lds
    s_add_u32 s26, s26, 256
    s_add_u32 s27, s27, 131072
    s_waitcnt vmcnt(4) lgkmcnt(0)
    s_barrier
    v_mfma_f32_16x16x32_bf16 v[128:131], v[108:111], v[76:79], v[128:131]
    ds_read_b128 v[28:31], v20 offset:0
    ds_read_b128 v[32:35], v20 offset:4096
    v_mfma_f32_16x16x32_bf16 v[132:135], v[108:111], v[80:83], v[132:135]
    ds_read_b64_tr_b16 v[60:61], v25 offset:0
    ds_read_b64_tr_b16 v[62:63], v25 offset:512
    ds_read_b128 v[36:39], v21 offset:0
    v_mfma_f32_16x16x32_bf16 v[128:131], v[112:115], v[84:87], v[128:131]
    ds_read_b128 v[40:43], v21 offset:4096
    ds_read_b64_tr_b16 v[64:65], v25 offset:4096
    ds_read_b64_tr_b16 v[66:67], v25 offset:4608
    v_mfma_f32_16x16x32_bf16 v[132:135], v[112:115], v[88:91], v[132:135]
    ds_read_b128 v[44:47], v22 offset:0
    ds_read_b128 v[48:51], v22 offset:4096
    ds_read_b64_tr_b16 v[68:69], v25 offset:8192
    v_mfma_f32_16x16x32_bf16 v[128:131], v[116:119], v[92:95], v[128:131]
    ds_read_b64_tr_b16 v[70:71], v25 offset:8704
    ds_read_b128 v[52:55], v23 offset:0
    v_mfma_f32_16x16x32_bf16 v[132:135], v[116:119], v[96:99], v[132:135]
    ds_read_b128 v[56:59], v23 offset:4096
    ds_read_b64_tr_b16 v[72:73], v25 offset:12288
    ds_read_b64_tr_b16 v[74:75], v25 offset:12800
    v_mfma_f32_16x16x32_bf16 v[128:131], v[120:123], v[100:103], v[128:131]
    s_add_u32 m0, s25, 0
    s_nop 0
    buffer_load_dwordx4 v8, s[8:11], s26 offen  lds
    s_add_u32 m0, s25, 16384
    s_nop 0
    buffer_load_dwordx4 v10, s[12:15], s27 offen  lds
    s_add_u32 m0, s25, 1024
    s_nop 0
    buffer_load_dwordx4 v9, s[8:11], s26 offen  lds
    v_mfma_f32_16x16x32_bf16 v[132:135], v[120:123], v[104:107], v[132:135]
    s_add_u32 m0, s25, 17408
    s_nop 0
    buffer_load_dwordx4 v11, s[12:15], s27 offen  lds
    s_add_u32 s26, s26, 256
    s_add_u32 s27, s27, 131072
    s_waitcnt vmcnt(4) lgkmcnt(0)
    s_barrier
    v_mfma_f32_16x16x32_bf16 v[128:131], v[60:63], v[28:31], v[128:131]
    ds_read_b128 v[76:79], v20 offset:32768
    ds_read_b128 v[80:83], v20 offset:36864
    v_mfma_f32_16x16x32_bf16 v[132:135], v[60:63], v[32:35], v[132:135]
    ds_read_b64_tr_b16 v[108:109], v25 offset:32768
    ds_read_b64_tr_b16 v[110:111], v25 offset:33280
    ds_read_b128 v[84:87], v21 offset:32768
    v_mfma_f32_16x16x32_bf16 v[128:131], v[64:67], v[36:39], v[128:131]
    ds_read_b128 v[88:91], v21 offset:36864
    ds_read_b64_tr_b16 v[112:113], v25 offset:36864
    ds_read_b64_tr_b16 v[114:115], v25 offset:37376
    v_mfma_f32_16x16x32_bf16 v[132:135], v[64:67], v[40:43], v[132:135]
    ds_read_b128 v[92:95], v22 offset:32768
    ds_read_b128 v[96:99], v22 offset:36864
    ds_read_b64_tr_b16 v[116:117], v25 offset:40960
    v_mfma_f32_16x16x32_bf16 v[128:131], v[68:71], v[44:47], v[128:131]
    ds_read_b64_tr_b16 v[118:119], v25 offset:41472
    ds_read_b128 v[100:103], v23 offset:32768
    v_mfma_f32_16x16x32_bf16 v[132:135], v[68:71], v[48:51], v[132:135]
    ds_read_b128 v[104:107], v23 offset:36864
    ds_read_b64_tr_b16 v[120:121], v25 offset:45056
    ds_read_b64_tr_b16 v[122:123], v25 offset:45568
    v_mfma_f32_16x16x32_bf16 v[128:131], v[72:75], v[52:55], v[128:131]
    s_add_u32 m0, s25, 32768
    s_nop 0
    buffer_load_dwordx4 v8, s[8:11], s26 offen  lds
    s_add_u32 m0, s25, 49152
    s_nop 0
    buffer_load_dwordx4 v10, s[12:15], s27 offen  lds
    s_add_u32 m0, s25, 33792
    s_nop 0
    buffer_load_dwordx4 v9, s[8:11], s26 offen  lds
    v_mfma_f32_16x16x32_bf16 v[132:135], v[72:75], v[56:59], v[132:135]
    s_add_u32 m0, s25, 50176
    s_nop 0
    buffer_load_dwordx4 v11, s[12:15], s27 offen  lds
    s_add_u32 s26, s26, 256
    s_add_u32 s27, s27, 131072
    s_waitcnt vmcnt(4) lgkmcnt(0)
    s_barrier
    v_mfma_f32_16x16x32_bf16 v[128:131], v[108:111], v[76:79], v[128:131]
    ds_read_b128 v[28:31], v16 offset:0
    ds_read_b128 v[32:35], v16 offset:4096
    v_mfma_f32_16x16x32_bf16 v[132:135], v[108:111], v[80:83], v[132:135]
    ds_read_b64_tr_b16 v[60:61], v24 offset:0
    ds_read_b64_tr_b16 v[62:63], v24 offset:512
    ds_read_b128 v[36:39], v17 offset:0
    v_mfma_f32_16x16x32_bf16 v[128:131], v[112:115], v[84:87], v[128:131]
    ds_read_b128 v[40:43], v17 offset:4096
    ds_read_b64_tr_b16 v[64:65], v24 offset:4096
    ds_read_b64_tr_b16 v[66:67], v24 offset:4608
    v_mfma_f32_16x16x32_bf16 v[132:135], v[112:115], v[88:91], v[132:135]
    ds_read_b128 v[44:47], v18 offset:0
    ds_read_b128 v[48:51], v18 offset:4096
    ds_read_b64_tr_b16 v[68:69], v24 offset:8192
    v_mfma_f32_16x16x32_bf16 v[128:131], v[116:119], v[92:95], v[128:131]
    ds_read_b64_tr_b16 v[70:71], v24 offset:8704
    ds_read_b128 v[52:55], v19 offset:0
    v_mfma_f32_16x16x32_bf16 v[132:135], v[116:119], v[96:99], v[132:135]
    ds_read_b128 v[56:59], v19 offset:4096
    ds_read_b64_tr_b16 v[72:73], v24 offset:12288
    ds_read_b64_tr_b16 v[74:75], v24 offset:12800
    v_mfma_f32_16x16x32_bf16 v[128:131], v[120:123], v[100:103], v[128:131]
    s_add_u32 m0, s25, 65536
    s_nop 0
    buffer_load_dwordx4 v8, s[8:11], s26 offen  lds
    s_add_u32 m0, s25, 81920
    s_nop 0
    buffer_load_dwordx4 v10, s[12:15], s27 offen  lds
    s_add_u32 m0, s25, 66560
    s_nop 0
    buffer_load_dwordx4 v9, s[8:11], s26 offen  lds
    v_mfma_f32_16x16x32_bf16 v[132:135], v[120:123], v[104:107], v[132:135]
    s_add_u32 m0, s25, 82944
    s_nop 0
    buffer_load_dwordx4 v11, s[12:15], s27 offen  lds
    s_add_u32 s26, s26, 256
    s_add_u32 s27, s27, 131072
    s_waitcnt vmcnt(4) lgkmcnt(0)
    s_barrier
    v_mfma_f32_16x16x32_bf16 v[128:131], v[60:63], v[28:31], v[128:131]
    ds_read_b128 v[76:79], v16 offset:32768
    ds_read_b128 v[80:83], v16 offset:36864
    v_mfma_f32_16x16x32_bf16 v[132:135], v[60:63], v[32:35], v[132:135]
    ds_read_b64_tr_b16 v[108:109], v24 offset:32768
    ds_read_b64_tr_b16 v[110:111], v24 offset:33280
    v_mfma_f32_16x16x32_bf16 v[128:131], v[64:67], v[36:39], v[128:131]
    ds_read_b128 v[84:87], v17 offset:32768
    ds_read_b128 v[88:91], v17 offset:36864
    v_mfma_f32_16x16x32_bf16 v[132:135], v[64:67], v[40:43], v[132:135]
    ds_read_b64_tr_b16 v[112:113], v24 offset:36864
    ds_read_b64_tr_b16 v[114:115], v24 offset:37376
    v_mfma_f32_16x16x32_bf16 v[128:131], v[68:71], v[44:47], v[128:131]
    ds_read_b128 v[92:95], v18 offset:32768
    ds_read_b128 v[96:99], v18 offset:36864
    v_mfma_f32_16x16x32_bf16 v[132:135], v[68:71], v[48:51], v[132:135]
    ds_read_b64_tr_b16 v[116:117], v24 offset:40960
    ds_read_b64_tr_b16 v[118:119], v24 offset:41472
    v_mfma_f32_16x16x32_bf16 v[128:131], v[72:75], v[52:55], v[128:131]
    ds_read_b128 v[100:103], v19 offset:32768
    ds_read_b128 v[104:107], v19 offset:36864
    v_mfma_f32_16x16x32_bf16 v[132:135], v[72:75], v[56:59], v[132:135]
    ds_read_b64_tr_b16 v[120:121], v24 offset:45056
    ds_read_b64_tr_b16 v[122:123], v24 offset:45568
    s_waitcnt vmcnt(0) lgkmcnt(0)
    s_barrier
    v_mfma_f32_16x16x32_bf16 v[128:131], v[108:111], v[76:79], v[128:131]
    ds_read_b128 v[28:31], v20 offset:0
    v_mfma_f32_16x16x32_bf16 v[132:135], v[108:111], v[80:83], v[132:135]
    ds_read_b128 v[32:35], v20 offset:4096
    ds_read_b64_tr_b16 v[60:61], v25 offset:0
    v_mfma_f32_16x16x32_bf16 v[128:131], v[112:115], v[84:87], v[128:131]
    ds_read_b64_tr_b16 v[62:63], v25 offset:512
    v_mfma_f32_16x16x32_bf16 v[132:135], v[112:115], v[88:91], v[132:135]
    ds_read_b128 v[36:39], v21 offset:0
    ds_read_b128 v[40:43], v21 offset:4096
    v_mfma_f32_16x16x32_bf16 v[128:131], v[116:119], v[92:95], v[128:131]
    ds_read_b64_tr_b16 v[64:65], v25 offset:4096
    v_mfma_f32_16x16x32_bf16 v[132:135], v[116:119], v[96:99], v[132:135]
    ds_read_b64_tr_b16 v[66:67], v25 offset:4608
    ds_read_b128 v[44:47], v22 offset:0
    v_mfma_f32_16x16x32_bf16 v[128:131], v[120:123], v[100:103], v[128:131]
    ds_read_b128 v[48:51], v22 offset:4096
    v_mfma_f32_16x16x32_bf16 v[132:135], v[120:123], v[104:107], v[132:135]
    ds_read_b64_tr_b16 v[68:69], v25 offset:8192
    ds_read_b64_tr_b16 v[70:71], v25 offset:8704
    s_waitcnt vmcnt(0) lgkmcnt(0)
    v_mfma_f32_16x16x32_bf16 v[128:131], v[60:63], v[28:31], v[128:131]
    v_mfma_f32_16x16x32_bf16 v[132:135], v[60:63], v[32:35], v[132:135]
    v_mfma_f32_16x16x32_bf16 v[128:131], v[64:67], v[36:39], v[128:131]
    v_mfma_f32_16x16x32_bf16 v[132:135], v[64:67], v[40:43], v[132:135]
    v_mfma_f32_16x16x32_bf16 v[128:131], v[68:71], v[44:47], v[128:131]
    v_mfma_f32_16x16x32_bf16 v[132:135], v[68:71], v[48:51], v[132:135]
    s_nop 7
    s_nop 1
    v_lshlrev_b32 v12, 16, v136
    v_and_b32 v13, 0xffff0000, v136
    v_lshlrev_b32 v14, 16, v137
    v_and_b32 v15, 0xffff0000, v137
    v_add_f32 v12, v12, v128
    v_add_f32 v13, v13, v129
    v_add_f32 v14, v14, v130
    v_add_f32 v15, v15, v131
    v_cvt_pk_bf16_f32 v136, v12, v13
    v_cvt_pk_bf16_f32 v137, v14, v15
    buffer_store_dwordx2 v[136:137], v6, s[44:47], s30 offen
    v_lshlrev_b32 v12, 16, v138
    v_and_b32 v13, 0xffff0000, v138
    v_lshlrev_b32 v14, 16, v139
    v_and_b32 v15, 0xffff0000, v139
    v_add_f32 v12, v12, v132
    v_add_f32 v13, v13, v133
    v_add_f32 v14, v14, v134
    v_add_f32 v15, v15, v135
    v_cvt_pk_bf16_f32 v138, v12, v13
    v_cvt_pk_bf16_f32 v139, v14, v15
    buffer_store_dwordx2 v[138:139], v7, s[44:47], s30 offen
k_down_kernel_done:
    s_endpgm
k_end_label:
.section .rodata,"a"
.p2align 6
.amdhsa_kernel k_qkv_kernel
  .amdhsa_next_free_vgpr 240
  .amdhsa_next_free_sgpr 102
  .amdhsa_accum_offset 240
  .amdhsa_group_segment_fixed_size 0
  .amdhsa_kernarg_size 80
  .amdhsa_user_sgpr_count 2
  .amdhsa_user_sgpr_kernarg_segment_ptr 1
  .amdhsa_system_sgpr_workgroup_id_x 1
.end_amdhsa_kernel
.p2align 6
.amdhsa_kernel k_attn_kernel
  .amdhsa_next_free_vgpr 128
  .amdhsa_next_free_sgpr 102
  .amdhsa_accum_offset 128
  .amdhsa_group_segment_fixed_size 0
  .amdhsa_kernarg_size 80
  .amdhsa_user_sgpr_count 2
  .amdhsa_user_sgpr_kernarg_segment_ptr 1
  .amdhsa_system_sgpr_workgroup_id_x 1
.end_amdhsa_kernel
.p2align 6
.amdhsa_kernel k_wo_kernel
  .amdhsa_next_free_vgpr 224
  .amdhsa_next_free_sgpr 102
  .amdhsa_accum_offset 224
  .amdhsa_group_segment_fixed_size 0
  .amdhsa_kernarg_size 80
  .amdhsa_user_sgpr_count 2
  .amdhsa_user_sgpr_kernarg_segment_ptr 1
  .amdhsa_system_sgpr_workgroup_id_x 1
.end_amdhsa_kernel
.p2align 6
.amdhsa_kernel k_gu_kernel
  .amdhsa_next_free_vgpr 224
  .amdhsa_next_free_sgpr 102
  .amdhsa_accum_offset 224
  .amdhsa_group_segment_fixed_size 0
  .amdhsa_kernarg_size 80
  .amdhsa_user_sgpr_count 2
  .amdhsa_user_sgpr_kernarg_segment_ptr 1
  .amdhsa_system_sgpr_workgroup_id_x 1
.end_amdhsa_kernel
.p2align 6
.amdhsa_kernel k_down_kernel
  .amdhsa_next_free_vgpr 224
  .amdhsa_next_free_sgpr 102
  .amdhsa_accum_offset 224
  .amdhsa_group_segment_fixed_size 0
  .amdhsa_kernarg_size 80
  .amdhsa_user_sgpr_count 2
  .amdhsa_user_sgpr_kernarg_segment_ptr 1
  .amdhsa_system_sgpr_workgroup_id_x 1
.end_amdhsa_kernel
```
